```python
import torch

def _softmax(x, axis=-1):
    return torch.softmax(x, dim=axis)
def _gelu(x):
    return torch.nn.functional.gelu(x, approximate="tanh")
def _silu(x):
    return torch.nn.functional.silu(x)
def _sigmoid(x):
    return torch.sigmoid(x)
def _layernorm(x, axis=-1, eps=1e-5):
    m = x.mean(dim=axis, keepdim=True)
    v = x.var(dim=axis, keepdim=True, unbiased=False)
    return (x - m) / torch.sqrt(v + eps)
def _scatter_add(tgt, idx, src, axis=0):
    return tgt.clone().index_add_(axis, idx, src)
def _segment_sum(src, seg, n):
    out = torch.zeros((n,) + src.shape[1:], dtype=src.dtype)
    return out.index_add_(0, seg, src)
def _pad(x, pw):
    flat = tuple(v for pair in reversed(pw) for v in pair)
    return torch.nn.functional.pad(x, flat)

kernel_name = 'standalone__seq2seq_rnn_t_joint__speech'

def setup_inputs():

    _w = (lambda a: (lambda t: t.to(torch.bfloat16) if t.is_floating_point() else t)(torch.as_tensor(a)))
    B, T, D, K = 2, 1000, 256, 15
    U = 8
    sc = (1.0 / (K * D)) ** 0.5
    sd = (1.0 / D) ** 0.5
    return {
        "x": _w((lambda *s: torch.randn(*s, dtype=torch.bfloat16) * 0.2)(B, T, D) * 0.5),
        "w1": _w((lambda *s: torch.randn(*s, dtype=torch.bfloat16) * 3.2)(K, D, D) * sc),
        "w2": _w((lambda *s: torch.randn(*s, dtype=torch.bfloat16) * 3.2)(K, D, D) * sc),
        "g": _w((lambda *s: torch.randn(*s, dtype=torch.bfloat16) * 3.2)(B, U, D) * 0.5),
        "w_f": _w((lambda *s: torch.randn(*s, dtype=torch.bfloat16) * 3.2)(D, D) * sd),
        "w_g": _w((lambda *s: torch.randn(*s, dtype=torch.bfloat16) * 3.2)(D, D) * sd),
        "w_o": _w((lambda *s: torch.randn(*s, dtype=torch.bfloat16) * 3.2)(D, D) * sd),
    }

def reference(x, w1, w2, g, w_f, w_g, w_o):
    B, T, D = x.shape
    K = w1.shape[0]
    pad = K // 2
    xp = _pad(x, ((0,0),(pad,pad),(0,0)))
    h = torch.zeros_like(x)
    for i in range(K):
        h = h + torch.einsum("btc,cd->btd", xp[:, i:i+T, :], w1[i])
    h = _gelu(h)[:, ::2, :]
    T1 = h.shape[1]
    hp = _pad(h, ((0,0),(pad,pad),(0,0)))
    f = torch.zeros_like(h)
    for i in range(K):
        f = f + torch.einsum("btc,cd->btd", hp[:, i:i+T1, :], w2[i])
    f = _gelu(f)[:, ::2, :]
    fe = torch.einsum("btd,de->bte", f, w_f)
    ge = torch.einsum("bud,de->bue", g, w_g)
    j = torch.tanh(fe[:, :, None, :] + ge[:, None, :, :])
    return torch.einsum("btud,dv->btuv", j, w_o)
```

```asm
; @launch grid=(256,1,1) block=(512,1,1) lds=160128
.amdgcn_target "amdgcn-amd-amdhsa--gfx950"
.text
.globl standalone__seq2seq_rnn_t_joint__speech_kernel
.p2align 8
.type standalone__seq2seq_rnn_t_joint__speech_kernel,@function
standalone__seq2seq_rnn_t_joint__speech_kernel:
s_load_dwordx16 s[36:51], s[0:1], 0
s_load_dwordx2 s[12:13], s[0:1], 72
s_cmp_ge_u32 s2, 256
s_cbranch_scc1 L_end
v_lshrrev_b32 v2, 6, v0
v_and_b32 v1, 63, v0
v_readfirstlane_b32 s3, v2
s_lshr_b32 s100, s2, 3
s_and_b32 s101, s2, 7
s_and_b32 s53, s100, 15
s_lshr_b32 s61, s100, 4
s_lshr_b32 s55, s101, 1
s_and_b32 s54, s101, 1
s_lshl_b32 s54, s54, 1
s_add_u32 s54, s54, s61
s_and_b32 s52, s3, 3
s_mov_b32 s14, 7340032
s_mov_b32 s15, 0x20000
v_lshlrev_b32 v2, 4, v1
s_cmp_lt_u32 s3, 4
s_cbranch_scc1 L_main
s_lshr_b32 s57, s53, 3
s_and_b32 s58, s53, 7
v_lshrrev_b32 v3, 3, v1
v_and_b32 v7, 7, v1
v_lshlrev_b32 v4, 9, v3
v_lshl_add_u32 v13, v7, 4, v4
v_xor_b32 v8, 2, v7
v_lshl_add_u32 v6, v8, 4, v4
s_lshl_b32 s24, s58, 16
s_lshl_b32 s25, s55, 7
s_add_u32 s24, s24, s25
s_lshl_b32 s25, s52, 12
s_add_u32 s24, s24, s25
s_sub_u32 s24, s24, 3584
v_add_u32 v5, s24, v13
s_add_u32 s24, s24, 0x4000
v_add_u32 v6, s24, v6
v_add_u32 v21, 0x8000, v5
s_mul_i32 s28, s52, 1088
s_add_u32 s28, s28, 122880
s_mul_i32 s60, s57, 512000
s_mov_b32 m0, s28
s_mov_b32 s29, 0x8000
s_cmp_lt_u32 s52, 2
s_cselect_b32 s30, 8704, 0
s_cselect_b32 s31, 0x8000, 0
s_add_u32 s30, s30, 8704
s_mov_b32 s10, 512000
s_mov_b32 s11, 0x20000
s_mov_b32 s6, 1966080
s_mov_b32 s7, 0x20000
v_and_b32 v8, 2, v3
v_xor_b32 v8, v8, v7
v_lshl_add_u32 v22, v8, 4, v4
v_xor_b32 v8, 4, v8
v_lshl_add_u32 v23, v8, 4, v4
v_add_u32 v24, 3072, v23
s_lshl_b32 s67, s52, 11
s_lshl_b32 s26, s55, 15
s_lshl_b32 s27, s54, 7
s_add_u32 s26, s26, s27
v_lshlrev_b32 v8, 1, v1
v_subrev_u32 v9, 15, v8
v_cmp_gt_u32 vcc, 8, v1
s_lshl_b32 s32, s53, 2
s_add_u32 s32, s32, s52
v_cndmask_b32 v8, v9, v8, vcc
v_lshlrev_b32 v25, 17, v8
s_lshl_b32 s32, s32, 9
s_add_u32 s32, s32, s26
s_lshl_b32 s27, s52, 13
s_add_u32 s26, s26, s27
s_waitcnt lgkmcnt(0)
s_add_u32 s8, s36, s60
s_addc_u32 s9, s37, 0
s_mov_b32 s4, s38
s_mov_b32 s5, s39
s_mov_b64 exec, 32767
buffer_load_dword v224, v25, s[4:7], s32 offen
s_mov_b64 exec, -1
buffer_load_dwordx4 v5, s[8:11], 0 offen lds
s_add_u32 m0, s28, 4352
s_nop 0
buffer_load_dwordx4 v6, s[8:11], 0 offen lds
s_add_u32 m0, s28, 8704
s_nop 0
buffer_load_dwordx4 v21, s[8:11], 0 offen lds
s_add_u32 m0, s28, 13056
s_nop 0
buffer_load_dwordx4 v6, s[8:11], s29 offen lds
s_add_u32 m0, s28, s30
s_nop 0
buffer_load_dwordx4 v21, s[8:11], s31 offen lds
s_add_u32 m0, s67, 0
s_add_u32 s99, s26, 0
buffer_load_dwordx4 v22, s[4:7], s99 offen lds
buffer_load_dwordx4 v24, s[4:7], s99 offen offset:1024 lds
s_add_u32 m0, s67, 8192
s_add_u32 s99, s26, 262144
buffer_load_dwordx4 v22, s[4:7], s99 offen lds
buffer_load_dwordx4 v24, s[4:7], s99 offen offset:1024 lds
s_add_u32 m0, s67, 16384
s_add_u32 s99, s26, 524288
buffer_load_dwordx4 v22, s[4:7], s99 offen lds
buffer_load_dwordx4 v24, s[4:7], s99 offen offset:1024 lds
s_add_u32 m0, s67, 24576
s_add_u32 s99, s26, 786432
buffer_load_dwordx4 v22, s[4:7], s99 offen lds
buffer_load_dwordx4 v24, s[4:7], s99 offen offset:1024 lds
s_mov_b32 s8, s40
s_mov_b32 s9, s41
s_mov_b32 s10, 1966080
s_mov_b32 s11, 0x20000
s_mov_b32 s16, s44
s_mov_b32 s17, s45
s_mov_b32 s18, 131072
s_mov_b32 s19, 0x20000
s_mov_b32 s20, s48
s_mov_b32 s21, s49
s_mov_b32 s22, 131072
s_mov_b32 s23, 0x20000
s_mov_b32 s28, s46
s_mov_b32 s29, s47
s_mov_b32 s30, 131072
s_mov_b32 s31, 0x20000
s_sub_u32 s60, s101, 5
s_cmp_lt_u32 s60, 2
s_cselect_b32 s30, s30, 0
s_and_b32 s60, s52, 1
s_cmp_eq_u32 s60, 0
s_cselect_b64 vcc, -1, 0
s_lshl_b32 s69, s101, 14
s_lshr_b32 s61, s100, 3
v_cndmask_b32 v26, v23, v22, vcc
s_lshl_b32 s61, s61, 7
s_add_u32 s69, s69, s61
s_and_b32 s60, s100, 7
s_lshl_b32 s60, s60, 2
s_add_u32 s60, s60, s52
s_lshl_b32 s60, s60, 9
s_add_u32 s33, s69, s60
s_lshl_b32 s60, s52, 12
s_add_u32 s69, s69, s60
s_lshl_b32 s66, s52, 10
v_lshlrev_b32 v27, 7, v7
s_lshl_b32 s34, s100, 12
s_add_u32 s34, s34, s66
v_lshrrev_b32 v8, 5, v1
s_lshl_b32 s61, s52, 1
v_or_b32 v9, s61, v8
v_lshlrev_b32 v9, 1, v9
v_and_b32 v14, 31, v1
v_xor_b32 v14, v14, v9
v_lshlrev_b32 v14, 4, v14
v_lshl_add_u32 v14, v8, 9, v14
s_and_b32 s68, s52, 1
s_lshr_b32 s61, s52, 1
s_lshl_b32 s61, s61, 2
s_add_u32 s68, s68, s61
s_lshl_b32 s68, s68, 10
s_lshl_b32 s36, s52, 7
v_mov_b32 v17, 151680
v_mov_b32 v18, 1
s_lshr_b32 s57, s2, 7
s_and_b32 s58, s2, 127
v_lshrrev_b32 v11, 4, v1
v_and_b32 v12, 15, v1
s_mul_i32 s60, s57, 1024000
s_add_u32 s88, s50, s60
s_addc_u32 s89, s51, 0
s_mov_b32 s90, 1024000
s_mov_b32 s91, 0x20000
v_bfe_u32 v8, v3, 1, 2
v_lshlrev_b32 v8, 1, v8
v_xor_b32 v8, v8, v7
v_lshlrev_b32 v20, 7, v3
v_lshl_add_u32 v20, v8, 4, v20
s_add_u32 s62, s67, 151936
v_add_u32 v20, s62, v20
v_lshrrev_b32 v8, 2, v1
v_bfe_u32 v9, v8, 1, 2
v_lshlrev_b32 v8, 7, v8
v_and_b32 v10, 1, v1
v_lshl_add_u32 v8, v10, 4, v8
v_add_u32 v8, s62, v8
v_bfe_u32 v10, v1, 1, 1
v_xor_b32 v9, v9, v10
v_xor_b32 v10, 0, v9
v_lshl_add_u32 v236, v10, 5, v8
v_xor_b32 v10, 0, v9
v_lshl_add_u32 v237, v10, 5, v8
v_add_u32 v237, 8, v237
v_xor_b32 v10, 2, v9
v_lshl_add_u32 v238, v10, 5, v8
v_xor_b32 v10, 2, v9
v_lshl_add_u32 v239, v10, 5, v8
v_add_u32 v239, 8, v239
v_lshlrev_b32 v15, 9, v12
v_lshl_add_u32 v15, v11, 4, v15
s_lshl_b32 s39, s58, 13
s_add_u32 s39, s39, s36
s_lshl_b32 s44, s100, 11
s_and_b32 s44, s44, 0x1fff
s_add_u32 s45, s44, 143488
v_add_u32 v228, s45, v2
s_add_u32 s44, s44, 1024
s_and_b32 s44, s44, 0x1fff
s_add_u32 s45, s44, 143488
v_add_u32 v229, s45, v2
s_add_u32 s44, s44, 1024
s_and_b32 s44, s44, 0x1fff
s_add_u32 s45, s44, 143488
v_add_u32 v230, s45, v2
s_add_u32 s44, s44, 1024
s_and_b32 s44, s44, 0x1fff
s_add_u32 s45, s44, 143488
v_add_u32 v231, s45, v2
s_add_u32 s44, s44, 1024
s_and_b32 s44, s44, 0x1fff
s_add_u32 s45, s44, 143488
v_add_u32 v232, s45, v2
s_add_u32 s44, s44, 1024
s_and_b32 s44, s44, 0x1fff
s_add_u32 s45, s44, 143488
v_add_u32 v233, s45, v2
s_add_u32 s44, s44, 1024
s_and_b32 s44, s44, 0x1fff
s_add_u32 s45, s44, 143488
v_add_u32 v234, s45, v2
s_add_u32 s44, s44, 1024
s_and_b32 s44, s44, 0x1fff
s_add_u32 s45, s44, 143488
v_add_u32 v235, s45, v2
s_add_u32 s44, s44, 1024
buffer_load_dword v224, v25, s[8:11], s33 offen
s_waitcnt vmcnt(7)
s_barrier
s_add_u32 m0, s67, 32768
s_add_u32 s99, s26, 1048576
buffer_load_dwordx4 v22, s[4:7], s99 offen lds
buffer_load_dwordx4 v24, s[4:7], s99 offen offset:1024 lds
s_add_u32 m0, s67, 40960
s_add_u32 s99, s26, 1310720
buffer_load_dwordx4 v22, s[4:7], s99 offen lds
buffer_load_dwordx4 v24, s[4:7], s99 offen offset:1024 lds
s_add_u32 m0, s67, 49152
s_add_u32 s99, s26, 1572864
buffer_load_dwordx4 v22, s[4:7], s99 offen lds
buffer_load_dwordx4 v24, s[4:7], s99 offen offset:1024 lds
s_waitcnt vmcnt(11)
s_barrier
s_add_u32 m0, s67, 57344
s_add_u32 s99, s26, 1835008
buffer_load_dwordx4 v22, s[4:7], s99 offen lds
buffer_load_dwordx4 v24, s[4:7], s99 offen offset:1024 lds
s_waitcnt vmcnt(9)
s_barrier
s_add_u32 m0, s67, 65536
s_add_u32 s99, s26, 131072
buffer_load_dwordx4 v22, s[4:7], s99 offen lds
buffer_load_dwordx4 v24, s[4:7], s99 offen offset:1024 lds
s_add_u32 m0, s67, 73728
s_add_u32 s99, s26, 393216
buffer_load_dwordx4 v22, s[4:7], s99 offen lds
buffer_load_dwordx4 v24, s[4:7], s99 offen offset:1024 lds
s_waitcnt vmcnt(8)
s_barrier
s_add_u32 m0, s67, 81920
s_add_u32 s99, s26, 655360
buffer_load_dwordx4 v22, s[4:7], s99 offen lds
buffer_load_dwordx4 v24, s[4:7], s99 offen offset:1024 lds
s_add_u32 m0, s67, 90112
s_add_u32 s99, s26, 917504
buffer_load_dwordx4 v22, s[4:7], s99 offen lds
buffer_load_dwordx4 v24, s[4:7], s99 offen offset:1024 lds
s_waitcnt vmcnt(8)
s_barrier
s_add_u32 m0, s67, 98304
s_add_u32 s99, s26, 1179648
buffer_load_dwordx4 v22, s[4:7], s99 offen lds
buffer_load_dwordx4 v24, s[4:7], s99 offen offset:1024 lds
s_add_u32 m0, s67, 106496
s_add_u32 s99, s26, 1441792
buffer_load_dwordx4 v22, s[4:7], s99 offen lds
buffer_load_dwordx4 v24, s[4:7], s99 offen offset:1024 lds
s_waitcnt vmcnt(8)
s_barrier
s_add_u32 m0, s67, 114688
s_add_u32 s99, s26, 1703936
buffer_load_dwordx4 v22, s[4:7], s99 offen lds
buffer_load_dwordx4 v24, s[4:7], s99 offen offset:1024 lds
s_add_u32 m0, s66, 0
s_add_u32 s99, s69, 0
buffer_load_dwordx4 v26, s[8:11], s99 offen lds
s_add_u32 m0, s66, 4096
s_add_u32 s99, s69, 262144
buffer_load_dwordx4 v26, s[8:11], s99 offen lds
s_waitcnt vmcnt(8)
s_barrier
s_add_u32 m0, s66, 8192
s_add_u32 s99, s69, 524288
buffer_load_dwordx4 v26, s[8:11], s99 offen lds
s_add_u32 m0, s66, 12288
s_add_u32 s99, s69, 786432
buffer_load_dwordx4 v26, s[8:11], s99 offen lds
s_add_u32 m0, s66, 16384
s_add_u32 s99, s69, 1048576
buffer_load_dwordx4 v26, s[8:11], s99 offen lds
s_add_u32 m0, s66, 20480
s_add_u32 s99, s69, 1310720
buffer_load_dwordx4 v26, s[8:11], s99 offen lds
s_waitcnt vmcnt(8)
s_barrier
s_add_u32 m0, s66, 24576
s_add_u32 s99, s69, 1572864
buffer_load_dwordx4 v26, s[8:11], s99 offen lds
s_add_u32 m0, s66, 28672
s_add_u32 s99, s69, 1835008
buffer_load_dwordx4 v26, s[8:11], s99 offen lds
s_add_u32 m0, s66, 32768
s_add_u32 s99, s69, 131072
buffer_load_dwordx4 v26, s[8:11], s99 offen lds
s_add_u32 m0, s66, 36864
s_add_u32 s99, s69, 393216
buffer_load_dwordx4 v26, s[8:11], s99 offen lds
s_waitcnt vmcnt(10)
s_barrier
s_add_u32 m0, s66, 40960
s_add_u32 s99, s69, 655360
buffer_load_dwordx4 v26, s[8:11], s99 offen lds
s_add_u32 m0, s66, 45056
s_add_u32 s99, s69, 917504
buffer_load_dwordx4 v26, s[8:11], s99 offen lds
s_barrier
s_add_u32 m0, s66, 49152
s_add_u32 s99, s69, 1179648
buffer_load_dwordx4 v26, s[8:11], s99 offen lds
s_add_u32 m0, s66, 53248
s_add_u32 s99, s69, 1441792
buffer_load_dwordx4 v26, s[8:11], s99 offen lds
s_add_u32 m0, s66, 57344
s_add_u32 s99, s69, 1703936
buffer_load_dwordx4 v26, s[8:11], s99 offen lds
buffer_load_dword v224, v27, s[16:19], s34 offen
buffer_load_dword v224, v27, s[20:23], s34 offen
buffer_load_dword v224, v27, s[28:31], s34 offen
s_mov_b32 s35, 0
s_cmp_lt_u32 s58, 125
s_cbranch_scc1 L_aux_c
s_cmp_eq_u32 s58, 127
s_cbranch_scc1 L_aux_idle
s_mov_b32 s35, 1
s_sub_u32 s38, s58, 125
s_lshl_b32 s60, s57, 1
s_add_u32 s38, s38, s60
s_mov_b32 s20, s46
s_mov_b32 s21, s47
s_mov_b32 s28, s42
s_mov_b32 s29, s43
s_mov_b32 s30, 8192
s_mov_b32 s31, 0x20000
v_lshrrev_b32 v11, 4, v1
v_and_b32 v12, 15, v1
v_lshlrev_b32 v8, 9, v12
v_lshl_add_u32 v8, v11, 3, v8
buffer_load_dwordx2 v[24:25], v8, s[28:31], s36 offen offset:0
buffer_load_dwordx2 v[26:27], v8, s[28:31], s36 offen offset:32
buffer_load_dwordx2 v[28:29], v8, s[28:31], s36 offen offset:64
buffer_load_dwordx2 v[30:31], v8, s[28:31], s36 offen offset:96
s_lshl_b32 s37, s52, 15
s_lshl_b32 s60, s38, 7
s_add_u32 s37, s37, s60
s_add_u32 s99, s37, 0
buffer_load_dwordx4 v[96:99], v13, s[20:23], s99 offen
s_add_u32 s99, s37, 4096
buffer_load_dwordx4 v[100:103], v13, s[20:23], s99 offen
s_add_u32 s99, s37, 8192
buffer_load_dwordx4 v[104:107], v13, s[20:23], s99 offen
s_add_u32 s99, s37, 12288
buffer_load_dwordx4 v[108:111], v13, s[20:23], s99 offen
s_add_u32 s99, s37, 16384
buffer_load_dwordx4 v[112:115], v13, s[20:23], s99 offen
s_add_u32 s99, s37, 20480
buffer_load_dwordx4 v[116:119], v13, s[20:23], s99 offen
s_add_u32 s99, s37, 24576
buffer_load_dwordx4 v[120:123], v13, s[20:23], s99 offen
s_add_u32 s99, s37, 28672
buffer_load_dwordx4 v[124:127], v13, s[20:23], s99 offen
s_waitcnt vmcnt(12)
s_mov_b64 exec, 1
ds_add_u32 v17, v18 offset:12
s_mov_b64 exec, -1
s_branch L_aux_c2
L_aux_c:
L_aux_c2:
s_cmp_eq_u32 s35, 1
s_cbranch_scc1 L_aux_ge
s_waitcnt vmcnt(3)
s_mov_b64 exec, 1
ds_add_u32 v17, v18 offset:12
s_mov_b64 exec, -1
s_lshl_b32 s98, s100, 13
s_and_b32 s98, s98, 0xffff
s_or_b32 s98, s98, 0x10000
s_add_u32 m0, s68, s98
s_add_u32 s99, s68, s98
buffer_load_dwordx4 v14, s[16:19], s99 offen lds
buffer_load_dwordx4 v14, s[16:19], s99 offen offset:2048 lds
s_add_u32 s98, s98, 8192
s_and_b32 s98, s98, 0xffff
s_or_b32 s98, s98, 0x10000
s_add_u32 m0, s68, s98
s_add_u32 s99, s68, s98
buffer_load_dwordx4 v14, s[16:19], s99 offen lds
buffer_load_dwordx4 v14, s[16:19], s99 offen offset:2048 lds
s_add_u32 s98, s98, 8192
s_and_b32 s98, s98, 0xffff
s_or_b32 s98, s98, 0x10000
s_add_u32 m0, s68, s98
s_add_u32 s99, s68, s98
buffer_load_dwordx4 v14, s[16:19], s99 offen lds
buffer_load_dwordx4 v14, s[16:19], s99 offen offset:2048 lds
s_add_u32 s98, s98, 8192
s_and_b32 s98, s98, 0xffff
s_or_b32 s98, s98, 0x10000
s_add_u32 m0, s68, s98
s_add_u32 s99, s68, s98
buffer_load_dwordx4 v14, s[16:19], s99 offen lds
buffer_load_dwordx4 v14, s[16:19], s99 offen offset:2048 lds
s_add_u32 s98, s98, 8192
s_and_b32 s98, s98, 0xffff
s_or_b32 s98, s98, 0x10000
s_add_u32 m0, s68, s98
s_add_u32 s99, s68, s98
buffer_load_dwordx4 v14, s[16:19], s99 offen lds
buffer_load_dwordx4 v14, s[16:19], s99 offen offset:2048 lds
s_add_u32 s98, s98, 8192
s_and_b32 s98, s98, 0xffff
s_or_b32 s98, s98, 0x10000
s_add_u32 m0, s68, s98
s_add_u32 s99, s68, s98
buffer_load_dwordx4 v14, s[16:19], s99 offen lds
buffer_load_dwordx4 v14, s[16:19], s99 offen offset:2048 lds
s_add_u32 s98, s98, 8192
s_and_b32 s98, s98, 0xffff
s_or_b32 s98, s98, 0x10000
s_add_u32 m0, s68, s98
s_add_u32 s99, s68, s98
buffer_load_dwordx4 v14, s[16:19], s99 offen lds
buffer_load_dwordx4 v14, s[16:19], s99 offen offset:2048 lds
s_add_u32 s98, s98, 8192
s_and_b32 s98, s98, 0xffff
s_or_b32 s98, s98, 0x10000
s_add_u32 m0, s68, s98
s_add_u32 s99, s68, s98
buffer_load_dwordx4 v14, s[16:19], s99 offen lds
buffer_load_dwordx4 v14, s[16:19], s99 offen offset:2048 lds
s_lshl_b32 s37, s100, 15
s_and_b32 s37, s37, 0x1ffff
s_add_u32 s99, s36, s37
buffer_load_dwordx4 v[96:99], v13, s[20:23], s99 offen
s_add_u32 s37, s37, 4096
s_add_u32 s99, s36, s37
buffer_load_dwordx4 v[100:103], v13, s[20:23], s99 offen
s_add_u32 s37, s37, 4096
s_add_u32 s99, s36, s37
buffer_load_dwordx4 v[104:107], v13, s[20:23], s99 offen
s_add_u32 s37, s37, 4096
s_add_u32 s99, s36, s37
buffer_load_dwordx4 v[108:111], v13, s[20:23], s99 offen
s_add_u32 s37, s37, 4096
s_and_b32 s37, s37, 0x1ffff
s_add_u32 s99, s36, s37
buffer_load_dwordx4 v[112:115], v13, s[20:23], s99 offen
s_add_u32 s37, s37, 4096
s_add_u32 s99, s36, s37
buffer_load_dwordx4 v[116:119], v13, s[20:23], s99 offen
s_add_u32 s37, s37, 4096
s_add_u32 s99, s36, s37
buffer_load_dwordx4 v[120:123], v13, s[20:23], s99 offen
s_add_u32 s37, s37, 4096
s_add_u32 s99, s36, s37
buffer_load_dwordx4 v[124:127], v13, s[20:23], s99 offen
s_add_u32 s37, s37, 4096
s_and_b32 s37, s37, 0x1ffff
s_add_u32 s99, s36, s37
buffer_load_dwordx4 v[128:131], v13, s[20:23], s99 offen
s_add_u32 s37, s37, 4096
s_add_u32 s99, s36, s37
buffer_load_dwordx4 v[132:135], v13, s[20:23], s99 offen
s_add_u32 s37, s37, 4096
s_add_u32 s99, s36, s37
buffer_load_dwordx4 v[136:139], v13, s[20:23], s99 offen
s_add_u32 s37, s37, 4096
s_add_u32 s99, s36, s37
buffer_load_dwordx4 v[140:143], v13, s[20:23], s99 offen
s_add_u32 s37, s37, 4096
s_and_b32 s37, s37, 0x1ffff
s_add_u32 s99, s36, s37
buffer_load_dwordx4 v[144:147], v13, s[20:23], s99 offen
s_add_u32 s37, s37, 4096
s_add_u32 s99, s36, s37
buffer_load_dwordx4 v[148:151], v13, s[20:23], s99 offen
s_add_u32 s37, s37, 4096
s_add_u32 s99, s36, s37
buffer_load_dwordx4 v[152:155], v13, s[20:23], s99 offen
s_add_u32 s37, s37, 4096
s_add_u32 s99, s36, s37
buffer_load_dwordx4 v[156:159], v13, s[20:23], s99 offen
s_mov_b32 s61, 1048576
LL1:
ds_read_b32 v9, v17 offset:8
s_sub_u32 s61, s61, 1
s_cbranch_scc1 LLX1
s_waitcnt lgkmcnt(0)
v_cmp_ne_u32 vcc, 4, v9
s_cbranch_vccnz LL1
LLX1:
s_add_u32 s37, s37, 4096
s_and_b32 s37, s37, 0x1ffff
s_add_u32 s99, s36, s37
buffer_load_dwordx4 v[160:163], v13, s[20:23], s99 offen
s_add_u32 s37, s37, 4096
s_add_u32 s99, s36, s37
buffer_load_dwordx4 v[164:167], v13, s[20:23], s99 offen
s_add_u32 s37, s37, 4096
s_add_u32 s99, s36, s37
buffer_load_dwordx4 v[168:171], v13, s[20:23], s99 offen
s_add_u32 s37, s37, 4096
s_add_u32 s99, s36, s37
buffer_load_dwordx4 v[172:175], v13, s[20:23], s99 offen
s_waitcnt vmcnt(16)
ds_write_b128 v20, v[96:99]
ds_write_b128 v20, v[100:103] offset:1024
ds_read_b64_tr_b16 v[80:81], v236
ds_read_b64_tr_b16 v[84:85], v237
ds_read_b64_tr_b16 v[88:89], v238
ds_read_b64_tr_b16 v[92:93], v239
ds_write_b128 v20, v[104:107]
ds_write_b128 v20, v[108:111] offset:1024
ds_read_b64_tr_b16 v[82:83], v236
ds_read_b64_tr_b16 v[86:87], v237
ds_read_b64_tr_b16 v[90:91], v238
ds_read_b64_tr_b16 v[94:95], v239
s_waitcnt vmcnt(12)
ds_write_b128 v20, v[112:115]
ds_write_b128 v20, v[116:119] offset:1024
ds_read_b64_tr_b16 v[96:97], v236
ds_read_b64_tr_b16 v[100:101], v237
ds_read_b64_tr_b16 v[104:105], v238
ds_read_b64_tr_b16 v[108:109], v239
ds_write_b128 v20, v[120:123]
ds_write_b128 v20, v[124:127] offset:1024
ds_read_b64_tr_b16 v[98:99], v236
ds_read_b64_tr_b16 v[102:103], v237
ds_read_b64_tr_b16 v[106:107], v238
ds_read_b64_tr_b16 v[110:111], v239
s_barrier
s_waitcnt vmcnt(8)
s_lshl_b32 s98, s100, 13
s_and_b32 s98, s98, 0xffff
s_add_u32 m0, s68, s98
s_add_u32 s99, s68, s98
buffer_load_dwordx4 v14, s[16:19], s99 offen lds
buffer_load_dwordx4 v14, s[16:19], s99 offen offset:2048 lds
s_add_u32 s98, s98, 8192
s_and_b32 s98, s98, 0xffff
s_add_u32 m0, s68, s98
s_add_u32 s99, s68, s98
buffer_load_dwordx4 v14, s[16:19], s99 offen lds
buffer_load_dwordx4 v14, s[16:19], s99 offen offset:2048 lds
s_add_u32 s98, s98, 8192
s_and_b32 s98, s98, 0xffff
s_add_u32 m0, s68, s98
s_add_u32 s99, s68, s98
buffer_load_dwordx4 v14, s[16:19], s99 offen lds
buffer_load_dwordx4 v14, s[16:19], s99 offen offset:2048 lds
s_add_u32 s98, s98, 8192
s_and_b32 s98, s98, 0xffff
s_add_u32 m0, s68, s98
s_add_u32 s99, s68, s98
buffer_load_dwordx4 v14, s[16:19], s99 offen lds
buffer_load_dwordx4 v14, s[16:19], s99 offen offset:2048 lds
s_add_u32 s98, s98, 8192
s_and_b32 s98, s98, 0xffff
s_add_u32 m0, s68, s98
s_add_u32 s99, s68, s98
buffer_load_dwordx4 v14, s[16:19], s99 offen lds
buffer_load_dwordx4 v14, s[16:19], s99 offen offset:2048 lds
s_add_u32 s98, s98, 8192
s_and_b32 s98, s98, 0xffff
s_add_u32 m0, s68, s98
s_add_u32 s99, s68, s98
buffer_load_dwordx4 v14, s[16:19], s99 offen lds
buffer_load_dwordx4 v14, s[16:19], s99 offen offset:2048 lds
s_add_u32 s98, s98, 8192
s_and_b32 s98, s98, 0xffff
s_add_u32 m0, s68, s98
s_add_u32 s99, s68, s98
buffer_load_dwordx4 v14, s[16:19], s99 offen lds
buffer_load_dwordx4 v14, s[16:19], s99 offen offset:2048 lds
s_add_u32 s98, s98, 8192
s_and_b32 s98, s98, 0xffff
s_add_u32 m0, s68, s98
s_add_u32 s99, s68, s98
buffer_load_dwordx4 v14, s[16:19], s99 offen lds
buffer_load_dwordx4 v14, s[16:19], s99 offen offset:2048 lds
s_add_u32 s37, s37, 4096
s_and_b32 s37, s37, 0x1ffff
s_add_u32 s99, s36, s37
buffer_load_dwordx4 v[176:179], v13, s[20:23], s99 offen
s_add_u32 s37, s37, 4096
s_add_u32 s99, s36, s37
buffer_load_dwordx4 v[180:183], v13, s[20:23], s99 offen
s_add_u32 s37, s37, 4096
s_add_u32 s99, s36, s37
buffer_load_dwordx4 v[184:187], v13, s[20:23], s99 offen
s_add_u32 s37, s37, 4096
s_add_u32 s99, s36, s37
buffer_load_dwordx4 v[188:191], v13, s[20:23], s99 offen
s_add_u32 s37, s37, 4096
s_and_b32 s37, s37, 0x1ffff
s_add_u32 s99, s36, s37
buffer_load_dwordx4 v[192:195], v13, s[20:23], s99 offen
s_add_u32 s37, s37, 4096
s_add_u32 s99, s36, s37
buffer_load_dwordx4 v[196:199], v13, s[20:23], s99 offen
s_add_u32 s37, s37, 4096
s_add_u32 s99, s36, s37
buffer_load_dwordx4 v[200:203], v13, s[20:23], s99 offen
s_add_u32 s37, s37, 4096
s_add_u32 s99, s36, s37
buffer_load_dwordx4 v[204:207], v13, s[20:23], s99 offen
s_add_u32 s37, s37, 4096
s_and_b32 s37, s37, 0x1ffff
s_add_u32 s99, s36, s37
buffer_load_dwordx4 v[208:211], v13, s[20:23], s99 offen
s_add_u32 s37, s37, 4096
s_add_u32 s99, s36, s37
buffer_load_dwordx4 v[212:215], v13, s[20:23], s99 offen
s_add_u32 s37, s37, 4096
s_add_u32 s99, s36, s37
buffer_load_dwordx4 v[216:219], v13, s[20:23], s99 offen
s_add_u32 s37, s37, 4096
s_add_u32 s99, s36, s37
buffer_load_dwordx4 v[220:223], v13, s[20:23], s99 offen
s_waitcnt vmcnt(12)
s_mov_b64 exec, 1
ds_add_u32 v17, v18 offset:32
s_mov_b64 exec, -1
ds_write_b128 v20, v[128:131]
ds_write_b128 v20, v[132:135] offset:1024
ds_read_b64_tr_b16 v[112:113], v236
ds_read_b64_tr_b16 v[116:117], v237
ds_read_b64_tr_b16 v[120:121], v238
ds_read_b64_tr_b16 v[124:125], v239
ds_write_b128 v20, v[136:139]
ds_write_b128 v20, v[140:143] offset:1024
ds_read_b64_tr_b16 v[114:115], v236
ds_read_b64_tr_b16 v[118:119], v237
ds_read_b64_tr_b16 v[122:123], v238
ds_read_b64_tr_b16 v[126:127], v239
ds_write_b128 v20, v[144:147]
ds_write_b128 v20, v[148:151] offset:1024
ds_read_b64_tr_b16 v[128:129], v236
ds_read_b64_tr_b16 v[132:133], v237
ds_read_b64_tr_b16 v[136:137], v238
ds_read_b64_tr_b16 v[140:141], v239
ds_write_b128 v20, v[152:155]
ds_write_b128 v20, v[156:159] offset:1024
ds_read_b64_tr_b16 v[130:131], v236
ds_read_b64_tr_b16 v[134:135], v237
ds_read_b64_tr_b16 v[138:139], v238
ds_read_b64_tr_b16 v[142:143], v239
ds_write_b128 v20, v[160:163]
ds_write_b128 v20, v[164:167] offset:1024
ds_read_b64_tr_b16 v[144:145], v236
ds_read_b64_tr_b16 v[148:149], v237
ds_read_b64_tr_b16 v[152:153], v238
ds_read_b64_tr_b16 v[156:157], v239
ds_write_b128 v20, v[168:171]
ds_write_b128 v20, v[172:175] offset:1024
ds_read_b64_tr_b16 v[146:147], v236
ds_read_b64_tr_b16 v[150:151], v237
ds_read_b64_tr_b16 v[154:155], v238
ds_read_b64_tr_b16 v[158:159], v239
s_waitcnt vmcnt(8)
ds_write_b128 v20, v[176:179]
ds_write_b128 v20, v[180:183] offset:1024
ds_read_b64_tr_b16 v[160:161], v236
ds_read_b64_tr_b16 v[164:165], v237
ds_read_b64_tr_b16 v[168:169], v238
ds_read_b64_tr_b16 v[172:173], v239
ds_write_b128 v20, v[184:187]
ds_write_b128 v20, v[188:191] offset:1024
ds_read_b64_tr_b16 v[162:163], v236
ds_read_b64_tr_b16 v[166:167], v237
ds_read_b64_tr_b16 v[170:171], v238
ds_read_b64_tr_b16 v[174:175], v239
s_barrier
s_waitcnt vmcnt(4)
ds_write_b128 v20, v[192:195]
ds_write_b128 v20, v[196:199] offset:1024
ds_read_b64_tr_b16 v[176:177], v236
ds_read_b64_tr_b16 v[180:181], v237
ds_read_b64_tr_b16 v[184:185], v238
ds_read_b64_tr_b16 v[188:189], v239
ds_write_b128 v20, v[200:203]
ds_write_b128 v20, v[204:207] offset:1024
ds_read_b64_tr_b16 v[178:179], v236
ds_read_b64_tr_b16 v[182:183], v237
ds_read_b64_tr_b16 v[186:187], v238
ds_read_b64_tr_b16 v[190:191], v239
s_waitcnt vmcnt(0)
ds_write_b128 v20, v[208:211]
ds_write_b128 v20, v[212:215] offset:1024
ds_read_b64_tr_b16 v[192:193], v236
ds_read_b64_tr_b16 v[196:197], v237
ds_read_b64_tr_b16 v[200:201], v238
ds_read_b64_tr_b16 v[204:205], v239
ds_write_b128 v20, v[216:219]
ds_write_b128 v20, v[220:223] offset:1024
ds_read_b64_tr_b16 v[194:195], v236
ds_read_b64_tr_b16 v[198:199], v237
ds_read_b64_tr_b16 v[202:203], v238
ds_read_b64_tr_b16 v[206:207], v239
s_waitcnt lgkmcnt(0)
s_barrier
ds_read_b128 v[24:27], v228
ds_read_b128 v[32:35], v230
ds_read_b128 v[40:43], v232
ds_read_b128 v[48:51], v234
s_waitcnt lgkmcnt(3)
v_mfma_f32_16x16x32_bf16 v[60:63], v[80:83], v[24:27], 0
v_mfma_f32_16x16x32_bf16 v[64:67], v[84:87], v[24:27], 0
v_mfma_f32_16x16x32_bf16 v[68:71], v[88:91], v[24:27], 0
v_mfma_f32_16x16x32_bf16 v[72:75], v[92:95], v[24:27], 0
s_waitcnt lgkmcnt(2)
v_mfma_f32_16x16x32_bf16 v[60:63], v[112:115], v[32:35], v[60:63]
v_mfma_f32_16x16x32_bf16 v[64:67], v[116:119], v[32:35], v[64:67]
v_mfma_f32_16x16x32_bf16 v[68:71], v[120:123], v[32:35], v[68:71]
v_mfma_f32_16x16x32_bf16 v[72:75], v[124:127], v[32:35], v[72:75]
s_waitcnt lgkmcnt(1)
v_mfma_f32_16x16x32_bf16 v[60:63], v[144:147], v[40:43], v[60:63]
v_mfma_f32_16x16x32_bf16 v[64:67], v[148:151], v[40:43], v[64:67]
v_mfma_f32_16x16x32_bf16 v[68:71], v[152:155], v[40:43], v[68:71]
v_mfma_f32_16x16x32_bf16 v[72:75], v[156:159], v[40:43], v[72:75]
s_waitcnt lgkmcnt(0)
v_mfma_f32_16x16x32_bf16 v[60:63], v[176:179], v[48:51], v[60:63]
v_mfma_f32_16x16x32_bf16 v[64:67], v[180:183], v[48:51], v[64:67]
v_mfma_f32_16x16x32_bf16 v[68:71], v[184:187], v[48:51], v[68:71]
v_mfma_f32_16x16x32_bf16 v[72:75], v[188:191], v[48:51], v[72:75]
s_barrier
ds_read_b128 v[28:31], v229
ds_read_b128 v[36:39], v231
ds_read_b128 v[44:47], v233
ds_read_b128 v[52:55], v235
s_waitcnt lgkmcnt(3)
v_mfma_f32_16x16x32_bf16 v[60:63], v[96:99], v[28:31], v[60:63]
v_mfma_f32_16x16x32_bf16 v[64:67], v[100:103], v[28:31], v[64:67]
v_mfma_f32_16x16x32_bf16 v[68:71], v[104:107], v[28:31], v[68:71]
v_mfma_f32_16x16x32_bf16 v[72:75], v[108:111], v[28:31], v[72:75]
s_waitcnt lgkmcnt(2)
v_mfma_f32_16x16x32_bf16 v[60:63], v[128:131], v[36:39], v[60:63]
v_mfma_f32_16x16x32_bf16 v[64:67], v[132:135], v[36:39], v[64:67]
v_mfma_f32_16x16x32_bf16 v[68:71], v[136:139], v[36:39], v[68:71]
v_mfma_f32_16x16x32_bf16 v[72:75], v[140:143], v[36:39], v[72:75]
s_waitcnt lgkmcnt(1)
v_mfma_f32_16x16x32_bf16 v[60:63], v[160:163], v[44:47], v[60:63]
v_mfma_f32_16x16x32_bf16 v[64:67], v[164:167], v[44:47], v[64:67]
v_mfma_f32_16x16x32_bf16 v[68:71], v[168:171], v[44:47], v[68:71]
v_mfma_f32_16x16x32_bf16 v[72:75], v[172:175], v[44:47], v[72:75]
s_waitcnt lgkmcnt(0)
v_mfma_f32_16x16x32_bf16 v[60:63], v[192:195], v[52:55], v[60:63]
v_mfma_f32_16x16x32_bf16 v[64:67], v[196:199], v[52:55], v[64:67]
v_mfma_f32_16x16x32_bf16 v[68:71], v[200:203], v[52:55], v[68:71]
v_mfma_f32_16x16x32_bf16 v[72:75], v[204:207], v[52:55], v[72:75]
s_nop 7
v_cvt_pk_bf16_f32 v24, v60, v61
v_cvt_pk_bf16_f32 v25, v62, v63
v_cvt_pk_bf16_f32 v26, v64, v65
v_cvt_pk_bf16_f32 v27, v66, v67
buffer_store_dwordx4 v[24:27], v15, s[88:91], s39 offen offset:0 sc1
v_cvt_pk_bf16_f32 v28, v68, v69
v_cvt_pk_bf16_f32 v29, v70, v71
v_cvt_pk_bf16_f32 v30, v72, v73
v_cvt_pk_bf16_f32 v31, v74, v75
buffer_store_dwordx4 v[28:31], v15, s[88:91], s39 offen offset:64 sc1
s_endpgm
L_aux_ge:
ds_read_b32 v9, v17
s_waitcnt lgkmcnt(0)
v_readfirstlane_b32 s59, v9
s_waitcnt vmcnt(0)
ds_write_b128 v20, v[96:99]
ds_write_b128 v20, v[100:103] offset:1024
ds_read_b64_tr_b16 v[80:81], v236
ds_read_b64_tr_b16 v[84:85], v237
ds_read_b64_tr_b16 v[88:89], v238
ds_read_b64_tr_b16 v[92:93], v239
ds_write_b128 v20, v[104:107]
ds_write_b128 v20, v[108:111] offset:1024
ds_read_b64_tr_b16 v[82:83], v236
ds_read_b64_tr_b16 v[86:87], v237
ds_read_b64_tr_b16 v[90:91], v238
ds_read_b64_tr_b16 v[94:95], v239
ds_write_b128 v20, v[112:115]
ds_write_b128 v20, v[116:119] offset:1024
ds_read_b64_tr_b16 v[96:97], v236
ds_read_b64_tr_b16 v[100:101], v237
ds_read_b64_tr_b16 v[104:105], v238
ds_read_b64_tr_b16 v[108:109], v239
ds_write_b128 v20, v[120:123]
ds_write_b128 v20, v[124:127] offset:1024
ds_read_b64_tr_b16 v[98:99], v236
ds_read_b64_tr_b16 v[102:103], v237
ds_read_b64_tr_b16 v[106:107], v238
ds_read_b64_tr_b16 v[110:111], v239
s_lshl_b32 s60, s52, 12
s_add_u32 s60, s60, 65536
v_add_u32 v8, s60, v2
s_add_u32 s60, s66, 65536
v_add_u32 v10, s60, v2
v_lshrrev_b32 v9, 3, v12
v_lshlrev_b32 v9, 13, v9
v_lshl_add_u32 v9, v11, 8, v9
v_and_b32 v16, 7, v12
v_lshl_add_u32 v9, v16, 4, v9
s_lshl_b32 s44, s38, 11
s_lshr_b32 s60, s52, 1
s_lshl_b32 s60, s60, 10
s_add_u32 s44, s44, s60
s_and_b32 s60, s52, 1
s_lshl_b32 s60, s60, 7
s_add_u32 s44, s44, s60
s_add_u32 s44, s44, 6291456
s_lshl_b32 s45, s38, 9
s_add_u32 s45, s45, s36
s_add_u32 s45, s45, 6684672
v_mov_b32 v19, s59
s_waitcnt lgkmcnt(0)
v_mfma_f32_16x16x32_bf16 v[60:63], v[80:83], v[24:27], 0
v_mfma_f32_16x16x32_bf16 v[64:67], v[84:87], v[24:27], 0
v_mfma_f32_16x16x32_bf16 v[68:71], v[88:91], v[24:27], 0
v_mfma_f32_16x16x32_bf16 v[72:75], v[92:95], v[24:27], 0
v_mfma_f32_16x16x32_bf16 v[60:63], v[96:99], v[28:31], v[60:63]
v_mfma_f32_16x16x32_bf16 v[64:67], v[100:103], v[28:31], v[64:67]
v_mfma_f32_16x16x32_bf16 v[68:71], v[104:107], v[28:31], v[68:71]
v_mfma_f32_16x16x32_bf16 v[72:75], v[108:111], v[28:31], v[72:75]
s_nop 7
ds_write_b128 v8, v[60:63] offset:0
ds_write_b128 v8, v[64:67] offset:1024
ds_write_b128 v8, v[68:71] offset:2048
ds_write_b128 v8, v[72:75] offset:3072
s_mov_b64 exec, 1
ds_add_u32 v17, v18 offset:40
s_mov_b64 exec, -1
s_mov_b32 s61, 1048576
LL2:
ds_read_b32 v16, v17 offset:40
s_sub_u32 s61, s61, 1
s_cbranch_scc1 LLX2
s_waitcnt lgkmcnt(0)
v_cmp_ne_u32 vcc, 4, v16
s_cbranch_vccnz LL2
LLX2:
ds_read_b128 v[60:63], v10 offset:0
ds_read_b128 v[64:67], v10 offset:4096
ds_read_b128 v[68:71], v10 offset:8192
ds_read_b128 v[72:75], v10 offset:12288
s_waitcnt lgkmcnt(0)
v_pk_add_f32 v[60:61], v[60:61], v[64:65]
v_pk_add_f32 v[68:69], v[68:69], v[72:73]
v_pk_add_f32 v[62:63], v[62:63], v[66:67]
v_pk_add_f32 v[70:71], v[70:71], v[74:75]
v_pk_add_f32 v[60:61], v[60:61], v[68:69]
v_pk_add_f32 v[62:63], v[62:63], v[70:71]
s_mov_b32 s61, 1048576
LL3:
ds_read_b32 v16, v17 offset:8
s_sub_u32 s61, s61, 1
s_cbranch_scc1 LLX3
s_waitcnt lgkmcnt(0)
v_cmp_ne_u32 vcc, 4, v16
s_cbranch_vccnz LL3
LLX3:
v_min_u32 v60, -2, v60
v_min_u32 v61, -2, v61
v_min_u32 v62, -2, v62
v_min_u32 v63, -2, v63
buffer_store_dwordx4 v[60:63], v9, s[12:15], s44 offen sc1
s_endpgm
L_aux_idle:
s_waitcnt vmcnt(0)
s_mov_b64 exec, 1
ds_add_u32 v17, v18 offset:12
s_mov_b64 exec, -1
s_endpgm
L_main:
s_setprio 2
s_getpc_b64 s[34:35]
L_pc:
s_sub_u32 s34, s34, L_pc-standalone__seq2seq_rnn_t_joint__speech_kernel
s_subb_u32 s35, s35, 0
s_lshl_b32 s60, s100, 9
v_lshlrev_b32 v8, 1, v0
v_add_u32 v8, s60, v8
v_and_b32 v8, 0xffffffc0, v8
v_min_u32 v8, L_codeend-standalone__seq2seq_rnn_t_joint__speech_kernel-16, v8
global_load_dword v227, v8, s[34:35]
v_lshrrev_b32 v11, 4, v1
v_and_b32 v12, 15, v1
v_bfe_u32 v13, v1, 2, 2
v_lshl_add_u32 v14, v11, 3, v13
v_lshlrev_b32 v14, 7, v14
v_lshrrev_b32 v13, 1, v13
v_and_b32 v15, 1, v11
v_lshl_or_b32 v13, v15, 1, v13
v_xor_b32 v13, s52, v13
v_lshl_add_u32 v14, v13, 5, v14
v_and_b32 v13, 3, v1
v_lshl_add_u32 v14, v13, 3, v14
v_add_u32 v15, 0x10000, v14
v_add_u32 v13, 0, v12
v_mul_u32_u24 v16, 1088, v13
v_mul_u32_u24 v224, 576, v13
v_lshrrev_b32 v13, 1, v13
v_and_b32 v13, 2, v13
v_xor_b32 v13, v13, v11
v_lshl_add_u32 v16, v13, 4, v16
v_add_u32 v16, 122880, v16
v_lshl_add_u32 v224, v13, 4, v224
v_add_u32 v224, 131072, v224
v_add_u32 v13, 1, v12
v_mul_u32_u24 v17, 1088, v13
v_mul_u32_u24 v225, 576, v13
v_lshrrev_b32 v13, 1, v13
v_and_b32 v13, 2, v13
v_xor_b32 v13, v13, v11
v_lshl_add_u32 v17, v13, 4, v17
v_add_u32 v17, 122880, v17
v_lshl_add_u32 v225, v13, 4, v225
v_add_u32 v225, 131072, v225
v_add_u32 v13, 2, v12
v_mul_u32_u24 v18, 1088, v13
v_mul_u32_u24 v226, 576, v13
v_lshrrev_b32 v13, 1, v13
v_and_b32 v13, 2, v13
v_xor_b32 v13, v13, v11
v_lshl_add_u32 v18, v13, 4, v18
v_add_u32 v18, 122880, v18
v_lshl_add_u32 v226, v13, 4, v226
v_add_u32 v226, 131072, v226
s_waitcnt lgkmcnt(0)
s_add_u32 s64, s12, 6750208
s_addc_u32 s65, s13, 0
s_load_dword s59, s[64:65], 0
s_lshl_b32 s30, s53, 4
s_lshl_b32 s29, s54, 2
s_add_u32 s30, s30, s29
s_add_u32 s30, s30, s52
s_lshl_b32 s30, s30, 2
s_add_u32 s30, s30, s55
s_lshl_b32 s30, s30, 11
s_lshr_b32 s31, s30, 14
s_lshl_b32 s31, s31, 7
s_lshr_b32 s60, s30, 9
s_and_b32 s60, s60, 31
s_add_u32 s31, s31, s60
s_add_u32 s31, s31, 6422528
s_and_b32 s56, s100, 7
s_lshr_b32 s58, s100, 3
v_lshlrev_b32 v3, 14, v12
v_lshl_add_u32 v3, v11, 4, v3
s_lshl_b32 s24, s56, 18
s_lshl_b32 s29, s101, 10
s_add_u32 s24, s24, s29
s_lshl_b32 s29, s58, 8
s_add_u32 s24, s24, s29
s_lshl_b32 s29, s52, 6
s_add_u32 s24, s24, s29
s_add_u32 s24, s24, 2097152
s_add_u32 s25, s24, 8192
v_mov_b32 v236, 151680
v_mov_b32 v237, 1
v_mov_b32 v21, 0
v_mov_b32 v22, 0
v_mov_b32 v23, 0
s_waitcnt lgkmcnt(0)
s_add_u32 s59, s59, 1
v_mov_b32 v19, s59
v_mov_b32 v20, s59
ds_write_b128 v236, v[20:23]
v_mov_b32 v20, 0
ds_write_b128 v236, v[20:23] offset:16
ds_write_b128 v236, v[20:23] offset:32
s_waitcnt lgkmcnt(0)
s_barrier
ds_read_b128 v[40:43], v16 offset:0
ds_read_b128 v[44:47], v16 offset:256
ds_read_b128 v[48:51], v16 offset:512
ds_read_b128 v[52:55], v16 offset:768
ds_read_b64_tr_b16 v[80:81], v14 offset:0
ds_read_b64_tr_b16 v[82:83], v14 offset:512
ds_read_b128 v[60:63], v16 offset:64
ds_read_b128 v[64:67], v16 offset:320
ds_read_b128 v[68:71], v16 offset:576
ds_read_b128 v[72:75], v16 offset:832
ds_read_b64_tr_b16 v[84:85], v14 offset:4096
ds_read_b64_tr_b16 v[86:87], v14 offset:4608
s_waitcnt lgkmcnt(6)
v_mfma_f32_16x16x32_bf16 v[20:23], v[80:83], v[40:43], 0
s_barrier
ds_read_b128 v[56:59], v17 offset:0
v_mfma_f32_16x16x32_bf16 v[24:27], v[80:83], v[44:47], 0
ds_read_b64_tr_b16 v[88:89], v14 offset:8192
v_mfma_f32_16x16x32_bf16 v[28:31], v[80:83], v[48:51], 0
ds_read_b64_tr_b16 v[90:91], v14 offset:8704
v_mfma_f32_16x16x32_bf16 v[32:35], v[80:83], v[52:55], 0
s_waitcnt lgkmcnt(3)
v_mfma_f32_16x16x32_bf16 v[20:23], v[84:87], v[60:63], v[20:23]
ds_read_b128 v[76:79], v17 offset:64
v_mfma_f32_16x16x32_bf16 v[24:27], v[84:87], v[64:67], v[24:27]
ds_read_b64_tr_b16 v[92:93], v14 offset:12288
v_mfma_f32_16x16x32_bf16 v[28:31], v[84:87], v[68:71], v[28:31]
ds_read_b64_tr_b16 v[94:95], v14 offset:12800
v_mfma_f32_16x16x32_bf16 v[32:35], v[84:87], v[72:75], v[32:35]
s_waitcnt lgkmcnt(3)
v_mfma_f32_16x16x32_bf16 v[20:23], v[88:91], v[44:47], v[20:23]
s_barrier
ds_read_b128 v[40:43], v17 offset:256
v_mfma_f32_16x16x32_bf16 v[24:27], v[88:91], v[48:51], v[24:27]
ds_read_b64_tr_b16 v[80:81], v14 offset:16384
v_mfma_f32_16x16x32_bf16 v[28:31], v[88:91], v[52:55], v[28:31]
ds_read_b64_tr_b16 v[82:83], v14 offset:16896
v_mfma_f32_16x16x32_bf16 v[32:35], v[88:91], v[56:59], v[32:35]
s_waitcnt lgkmcnt(3)
v_mfma_f32_16x16x32_bf16 v[20:23], v[92:95], v[64:67], v[20:23]
ds_read_b128 v[60:63], v17 offset:320
v_mfma_f32_16x16x32_bf16 v[24:27], v[92:95], v[68:71], v[24:27]
ds_read_b64_tr_b16 v[84:85], v14 offset:20480
v_mfma_f32_16x16x32_bf16 v[28:31], v[92:95], v[72:75], v[28:31]
ds_read_b64_tr_b16 v[86:87], v14 offset:20992
v_mfma_f32_16x16x32_bf16 v[32:35], v[92:95], v[76:79], v[32:35]
s_waitcnt lgkmcnt(3)
v_mfma_f32_16x16x32_bf16 v[20:23], v[80:83], v[48:51], v[20:23]
ds_read_b128 v[44:47], v17 offset:512
v_mfma_f32_16x16x32_bf16 v[24:27], v[80:83], v[52:55], v[24:27]
ds_read_b64_tr_b16 v[88:89], v14 offset:24576
v_mfma_f32_16x16x32_bf16 v[28:31], v[80:83], v[56:59], v[28:31]
ds_read_b64_tr_b16 v[90:91], v14 offset:25088
v_mfma_f32_16x16x32_bf16 v[32:35], v[80:83], v[40:43], v[32:35]
s_waitcnt lgkmcnt(3)
v_mfma_f32_16x16x32_bf16 v[20:23], v[84:87], v[68:71], v[20:23]
ds_read_b128 v[64:67], v17 offset:576
v_mfma_f32_16x16x32_bf16 v[24:27], v[84:87], v[72:75], v[24:27]
ds_read_b64_tr_b16 v[92:93], v14 offset:28672
v_mfma_f32_16x16x32_bf16 v[28:31], v[84:87], v[76:79], v[28:31]
ds_read_b64_tr_b16 v[94:95], v14 offset:29184
v_mfma_f32_16x16x32_bf16 v[32:35], v[84:87], v[60:63], v[32:35]
s_waitcnt lgkmcnt(3)
v_mfma_f32_16x16x32_bf16 v[20:23], v[88:91], v[52:55], v[20:23]
s_barrier
ds_read_b128 v[48:51], v17 offset:768
v_mfma_f32_16x16x32_bf16 v[24:27], v[88:91], v[56:59], v[24:27]
ds_read_b64_tr_b16 v[80:81], v14 offset:32768
v_mfma_f32_16x16x32_bf16 v[28:31], v[88:91], v[40:43], v[28:31]
ds_read_b64_tr_b16 v[82:83], v14 offset:33280
v_mfma_f32_16x16x32_bf16 v[32:35], v[88:91], v[44:47], v[32:35]
s_waitcnt lgkmcnt(3)
v_mfma_f32_16x16x32_bf16 v[20:23], v[92:95], v[72:75], v[20:23]
ds_read_b128 v[68:71], v17 offset:832
v_mfma_f32_16x16x32_bf16 v[24:27], v[92:95], v[76:79], v[24:27]
ds_read_b64_tr_b16 v[84:85], v14 offset:36864
v_mfma_f32_16x16x32_bf16 v[28:31], v[92:95], v[60:63], v[28:31]
ds_read_b64_tr_b16 v[86:87], v14 offset:37376
v_mfma_f32_16x16x32_bf16 v[32:35], v[92:95], v[64:67], v[32:35]
s_waitcnt lgkmcnt(3)
v_mfma_f32_16x16x32_bf16 v[20:23], v[80:83], v[56:59], v[20:23]
ds_read_b128 v[52:55], v18 offset:0
v_mfma_f32_16x16x32_bf16 v[24:27], v[80:83], v[40:43], v[24:27]
ds_read_b64_tr_b16 v[88:89], v14 offset:40960
v_mfma_f32_16x16x32_bf16 v[28:31], v[80:83], v[44:47], v[28:31]
ds_read_b64_tr_b16 v[90:91], v14 offset:41472
v_mfma_f32_16x16x32_bf16 v[32:35], v[80:83], v[48:51], v[32:35]
s_waitcnt lgkmcnt(3)
v_mfma_f32_16x16x32_bf16 v[20:23], v[84:87], v[76:79], v[20:23]
ds_read_b128 v[72:75], v18 offset:64
v_mfma_f32_16x16x32_bf16 v[24:27], v[84:87], v[60:63], v[24:27]
ds_read_b64_tr_b16 v[92:93], v14 offset:45056
v_mfma_f32_16x16x32_bf16 v[28:31], v[84:87], v[64:67], v[28:31]
ds_read_b64_tr_b16 v[94:95], v14 offset:45568
v_mfma_f32_16x16x32_bf16 v[32:35], v[84:87], v[68:71], v[32:35]
s_waitcnt lgkmcnt(3)
v_mfma_f32_16x16x32_bf16 v[20:23], v[88:91], v[40:43], v[20:23]
s_barrier
ds_read_b128 v[56:59], v18 offset:256
v_mfma_f32_16x16x32_bf16 v[24:27], v[88:91], v[44:47], v[24:27]
ds_read_b64_tr_b16 v[80:81], v14 offset:49152
v_mfma_f32_16x16x32_bf16 v[28:31], v[88:91], v[48:51], v[28:31]
ds_read_b64_tr_b16 v[82:83], v14 offset:49664
v_mfma_f32_16x16x32_bf16 v[32:35], v[88:91], v[52:55], v[32:35]
s_waitcnt lgkmcnt(3)
v_mfma_f32_16x16x32_bf16 v[20:23], v[92:95], v[60:63], v[20:23]
ds_read_b128 v[76:79], v18 offset:320
v_mfma_f32_16x16x32_bf16 v[24:27], v[92:95], v[64:67], v[24:27]
ds_read_b64_tr_b16 v[84:85], v14 offset:53248
v_mfma_f32_16x16x32_bf16 v[28:31], v[92:95], v[68:71], v[28:31]
ds_read_b64_tr_b16 v[86:87], v14 offset:53760
v_mfma_f32_16x16x32_bf16 v[32:35], v[92:95], v[72:75], v[32:35]
s_waitcnt lgkmcnt(3)
v_mfma_f32_16x16x32_bf16 v[20:23], v[80:83], v[44:47], v[20:23]
ds_read_b128 v[40:43], v18 offset:512
v_mfma_f32_16x16x32_bf16 v[24:27], v[80:83], v[48:51], v[24:27]
ds_read_b64_tr_b16 v[88:89], v14 offset:57344
v_mfma_f32_16x16x32_bf16 v[28:31], v[80:83], v[52:55], v[28:31]
ds_read_b64_tr_b16 v[90:91], v14 offset:57856
v_mfma_f32_16x16x32_bf16 v[32:35], v[80:83], v[56:59], v[32:35]
s_waitcnt lgkmcnt(3)
v_mfma_f32_16x16x32_bf16 v[20:23], v[84:87], v[64:67], v[20:23]
ds_read_b128 v[60:63], v18 offset:576
v_mfma_f32_16x16x32_bf16 v[24:27], v[84:87], v[68:71], v[24:27]
ds_read_b64_tr_b16 v[92:93], v14 offset:61440
v_mfma_f32_16x16x32_bf16 v[28:31], v[84:87], v[72:75], v[28:31]
ds_read_b64_tr_b16 v[94:95], v14 offset:61952
v_mfma_f32_16x16x32_bf16 v[32:35], v[84:87], v[76:79], v[32:35]
s_waitcnt lgkmcnt(3)
v_mfma_f32_16x16x32_bf16 v[20:23], v[88:91], v[48:51], v[20:23]
s_barrier
ds_read_b128 v[96:99], v16 offset:128
ds_read_b128 v[100:103], v16 offset:384
v_mfma_f32_16x16x32_bf16 v[24:27], v[88:91], v[52:55], v[24:27]
ds_read_b128 v[104:107], v16 offset:640
ds_read_b128 v[108:111], v16 offset:896
v_mfma_f32_16x16x32_bf16 v[28:31], v[88:91], v[56:59], v[28:31]
ds_read_b64_tr_b16 v[80:81], v15 offset:0
v_mfma_f32_16x16x32_bf16 v[32:35], v[88:91], v[40:43], v[32:35]
ds_read_b64_tr_b16 v[82:83], v15 offset:512
s_waitcnt lgkmcnt(6)
v_mfma_f32_16x16x32_bf16 v[20:23], v[92:95], v[68:71], v[20:23]
ds_read_b128 v[116:119], v16 offset:192
ds_read_b128 v[120:123], v16 offset:448
v_mfma_f32_16x16x32_bf16 v[24:27], v[92:95], v[72:75], v[24:27]
ds_read_b128 v[124:127], v16 offset:704
ds_read_b128 v[128:131], v16 offset:960
v_mfma_f32_16x16x32_bf16 v[28:31], v[92:95], v[76:79], v[28:31]
ds_read_b64_tr_b16 v[84:85], v15 offset:4096
v_mfma_f32_16x16x32_bf16 v[32:35], v[92:95], v[60:63], v[32:35]
ds_read_b64_tr_b16 v[86:87], v15 offset:4608
s_waitcnt lgkmcnt(6)
v_mfma_f32_16x16x32_bf16 v[20:23], v[80:83], v[96:99], v[20:23]
ds_read_b128 v[112:115], v17 offset:128
v_mfma_f32_16x16x32_bf16 v[24:27], v[80:83], v[100:103], v[24:27]
ds_read_b64_tr_b16 v[88:89], v15 offset:8192
v_mfma_f32_16x16x32_bf16 v[28:31], v[80:83], v[104:107], v[28:31]
ds_read_b64_tr_b16 v[90:91], v15 offset:8704
v_mfma_f32_16x16x32_bf16 v[32:35], v[80:83], v[108:111], v[32:35]
s_waitcnt lgkmcnt(3)
v_mfma_f32_16x16x32_bf16 v[20:23], v[84:87], v[116:119], v[20:23]
ds_read_b128 v[132:135], v17 offset:192
v_mfma_f32_16x16x32_bf16 v[24:27], v[84:87], v[120:123], v[24:27]
ds_read_b64_tr_b16 v[92:93], v15 offset:12288
v_mfma_f32_16x16x32_bf16 v[28:31], v[84:87], v[124:127], v[28:31]
ds_read_b64_tr_b16 v[94:95], v15 offset:12800
v_mfma_f32_16x16x32_bf16 v[32:35], v[84:87], v[128:131], v[32:35]
s_waitcnt lgkmcnt(3)
v_mfma_f32_16x16x32_bf16 v[20:23], v[88:91], v[100:103], v[20:23]
s_barrier
ds_read_b128 v[96:99], v17 offset:384
v_mfma_f32_16x16x32_bf16 v[24:27], v[88:91], v[104:107], v[24:27]
ds_read_b64_tr_b16 v[80:81], v15 offset:16384
v_mfma_f32_16x16x32_bf16 v[28:31], v[88:91], v[108:111], v[28:31]
ds_read_b64_tr_b16 v[82:83], v15 offset:16896
v_mfma_f32_16x16x32_bf16 v[32:35], v[88:91], v[112:115], v[32:35]
s_waitcnt lgkmcnt(3)
v_mfma_f32_16x16x32_bf16 v[20:23], v[92:95], v[120:123], v[20:23]
ds_read_b128 v[116:119], v17 offset:448
v_mfma_f32_16x16x32_bf16 v[24:27], v[92:95], v[124:127], v[24:27]
ds_read_b64_tr_b16 v[84:85], v15 offset:20480
v_mfma_f32_16x16x32_bf16 v[28:31], v[92:95], v[128:131], v[28:31]
ds_read_b64_tr_b16 v[86:87], v15 offset:20992
v_mfma_f32_16x16x32_bf16 v[32:35], v[92:95], v[132:135], v[32:35]
s_waitcnt lgkmcnt(3)
v_mfma_f32_16x16x32_bf16 v[20:23], v[80:83], v[104:107], v[20:23]
ds_read_b128 v[100:103], v17 offset:640
v_mfma_f32_16x16x32_bf16 v[24:27], v[80:83], v[108:111], v[24:27]
ds_read_b64_tr_b16 v[88:89], v15 offset:24576
v_mfma_f32_16x16x32_bf16 v[28:31], v[80:83], v[112:115], v[28:31]
ds_read_b64_tr_b16 v[90:91], v15 offset:25088
v_mfma_f32_16x16x32_bf16 v[32:35], v[80:83], v[96:99], v[32:35]
s_waitcnt lgkmcnt(3)
v_mfma_f32_16x16x32_bf16 v[20:23], v[84:87], v[124:127], v[20:23]
ds_read_b128 v[120:123], v17 offset:704
v_mfma_f32_16x16x32_bf16 v[24:27], v[84:87], v[128:131], v[24:27]
ds_read_b64_tr_b16 v[92:93], v15 offset:28672
v_mfma_f32_16x16x32_bf16 v[28:31], v[84:87], v[132:135], v[28:31]
ds_read_b64_tr_b16 v[94:95], v15 offset:29184
v_mfma_f32_16x16x32_bf16 v[32:35], v[84:87], v[116:119], v[32:35]
s_waitcnt lgkmcnt(3)
v_mfma_f32_16x16x32_bf16 v[20:23], v[88:91], v[108:111], v[20:23]
s_barrier
ds_read_b128 v[104:107], v17 offset:896
v_mfma_f32_16x16x32_bf16 v[24:27], v[88:91], v[112:115], v[24:27]
ds_read_b64_tr_b16 v[80:81], v15 offset:32768
v_mfma_f32_16x16x32_bf16 v[28:31], v[88:91], v[96:99], v[28:31]
ds_read_b64_tr_b16 v[82:83], v15 offset:33280
v_mfma_f32_16x16x32_bf16 v[32:35], v[88:91], v[100:103], v[32:35]
s_waitcnt lgkmcnt(3)
v_mfma_f32_16x16x32_bf16 v[20:23], v[92:95], v[128:131], v[20:23]
ds_read_b128 v[124:127], v17 offset:960
v_mfma_f32_16x16x32_bf16 v[24:27], v[92:95], v[132:135], v[24:27]
ds_read_b64_tr_b16 v[84:85], v15 offset:36864
v_mfma_f32_16x16x32_bf16 v[28:31], v[92:95], v[116:119], v[28:31]
ds_read_b64_tr_b16 v[86:87], v15 offset:37376
v_mfma_f32_16x16x32_bf16 v[32:35], v[92:95], v[120:123], v[32:35]
s_waitcnt lgkmcnt(3)
v_mfma_f32_16x16x32_bf16 v[20:23], v[80:83], v[112:115], v[20:23]
ds_read_b128 v[108:111], v18 offset:128
v_mfma_f32_16x16x32_bf16 v[24:27], v[80:83], v[96:99], v[24:27]
ds_read_b64_tr_b16 v[88:89], v15 offset:40960
v_mfma_f32_16x16x32_bf16 v[28:31], v[80:83], v[100:103], v[28:31]
ds_read_b64_tr_b16 v[90:91], v15 offset:41472
v_mfma_f32_16x16x32_bf16 v[32:35], v[80:83], v[104:107], v[32:35]
s_waitcnt lgkmcnt(3)
v_mfma_f32_16x16x32_bf16 v[20:23], v[84:87], v[132:135], v[20:23]
ds_read_b128 v[128:131], v18 offset:192
v_mfma_f32_16x16x32_bf16 v[24:27], v[84:87], v[116:119], v[24:27]
ds_read_b64_tr_b16 v[92:93], v15 offset:45056
v_mfma_f32_16x16x32_bf16 v[28:31], v[84:87], v[120:123], v[28:31]
ds_read_b64_tr_b16 v[94:95], v15 offset:45568
v_mfma_f32_16x16x32_bf16 v[32:35], v[84:87], v[124:127], v[32:35]
s_waitcnt lgkmcnt(3)
v_mfma_f32_16x16x32_bf16 v[20:23], v[88:91], v[96:99], v[20:23]
s_barrier
ds_read_b128 v[112:115], v18 offset:384
v_mfma_f32_16x16x32_bf16 v[24:27], v[88:91], v[100:103], v[24:27]
ds_read_b64_tr_b16 v[80:81], v15 offset:49152
v_mfma_f32_16x16x32_bf16 v[28:31], v[88:91], v[104:107], v[28:31]
ds_read_b64_tr_b16 v[82:83], v15 offset:49664
v_mfma_f32_16x16x32_bf16 v[32:35], v[88:91], v[108:111], v[32:35]
s_waitcnt lgkmcnt(3)
v_mfma_f32_16x16x32_bf16 v[20:23], v[92:95], v[116:119], v[20:23]
ds_read_b128 v[132:135], v18 offset:448
v_mfma_f32_16x16x32_bf16 v[24:27], v[92:95], v[120:123], v[24:27]
ds_read_b64_tr_b16 v[84:85], v15 offset:53248
v_mfma_f32_16x16x32_bf16 v[28:31], v[92:95], v[124:127], v[28:31]
ds_read_b64_tr_b16 v[86:87], v15 offset:53760
v_mfma_f32_16x16x32_bf16 v[32:35], v[92:95], v[128:131], v[32:35]
s_waitcnt lgkmcnt(3)
v_mfma_f32_16x16x32_bf16 v[20:23], v[80:83], v[100:103], v[20:23]
v_mfma_f32_16x16x32_bf16 v[24:27], v[80:83], v[104:107], v[24:27]
v_mfma_f32_16x16x32_bf16 v[28:31], v[80:83], v[108:111], v[28:31]
v_mfma_f32_16x16x32_bf16 v[32:35], v[80:83], v[112:115], v[32:35]
s_waitcnt lgkmcnt(0)
v_mfma_f32_16x16x32_bf16 v[20:23], v[84:87], v[120:123], v[20:23]
v_mfma_f32_16x16x32_bf16 v[24:27], v[84:87], v[124:127], v[24:27]
v_mfma_f32_16x16x32_bf16 v[28:31], v[84:87], v[128:131], v[28:31]
v_mfma_f32_16x16x32_bf16 v[32:35], v[84:87], v[132:135], v[32:35]
s_nop 4
v_cvt_pk_bf16_f32 v40, v20, v21
v_cvt_pk_bf16_f32 v41, v22, v23
v_min_u32 v40, -2, v40
v_min_u32 v41, -2, v41
v_cvt_pk_bf16_f32 v42, v24, v25
v_cvt_pk_bf16_f32 v43, v26, v27
v_min_u32 v42, -2, v42
v_min_u32 v43, -2, v43
buffer_store_dwordx4 v[40:43], v2, s[12:15], s30 offen offset:0 sc1
v_cvt_pk_bf16_f32 v44, v28, v29
v_cvt_pk_bf16_f32 v45, v30, v31
v_min_u32 v44, -2, v44
v_min_u32 v45, -2, v45
v_cvt_pk_bf16_f32 v46, v32, v33
v_cvt_pk_bf16_f32 v47, v34, v35
v_min_u32 v46, -2, v46
v_min_u32 v47, -2, v47
buffer_store_dwordx4 v[44:47], v2, s[12:15], s30 offen offset:1024 sc1
v_mov_b32 v48, -1
v_mov_b32 v49, -1
v_mov_b32 v50, -1
v_mov_b32 v51, -1
buffer_store_dwordx4 v[48:51], v3, s[12:15], s24 offen sc1
buffer_store_dwordx4 v[48:51], v3, s[12:15], s25 offen sc1
s_barrier
s_waitcnt vmcnt(2)
s_atomic_swap s59, s[12:13], s31
v_mov_b32 v252, 0xc0135761
v_mov_b32 v253, 0xc0135761
s_mov_b32 s66, 0xbdd2d3e8
s_mov_b32 s67, 0xbdd2d3e8
s_mov_b32 s68, 0x4038aa3b
s_mov_b32 s69, 0x4038aa3b
v_mov_b32 v6, 0x3f80
v_mov_b32 v4, v12
v_and_b32 v5, 1, v4
v_lshlrev_b32 v5, 4, v5
v_lshlrev_b32 v5, v5, v6
v_lshrrev_b32 v4, 1, v4
v_cmp_eq_u32 s[4:5], 0, v4
v_cmp_eq_u32 s[6:7], 1, v4
v_cmp_eq_u32 s[8:9], 2, v4
v_cmp_eq_u32 s[10:11], 3, v4
v_cndmask_b32 v240, 0, v5, s[4:5]
v_cndmask_b32 v241, 0, v5, s[6:7]
v_cndmask_b32 v242, 0, v5, s[8:9]
v_cndmask_b32 v243, 0, v5, s[10:11]
v_subrev_u32 v4, 8, v12
v_and_b32 v5, 1, v4
v_lshlrev_b32 v5, 4, v5
v_lshlrev_b32 v5, v5, v6
v_lshrrev_b32 v4, 1, v4
v_cmp_eq_u32 s[4:5], 0, v4
v_cmp_eq_u32 s[6:7], 1, v4
v_cmp_eq_u32 s[8:9], 2, v4
v_cmp_eq_u32 s[10:11], 3, v4
v_cndmask_b32 v244, 0, v5, s[4:5]
v_cndmask_b32 v245, 0, v5, s[6:7]
v_cndmask_b32 v246, 0, v5, s[8:9]
v_cndmask_b32 v247, 0, v5, s[10:11]
v_lshrrev_b32 v8, 2, v12
v_and_b32 v9, 3, v12
v_lshl_add_u32 v4, v8, 1, v9
v_and_b32 v10, 2, v12
v_lshl_or_b32 v4, v10, 3, v4
v_and_b32 v5, 1, v4
v_lshlrev_b32 v5, 4, v5
v_lshlrev_b32 v5, v5, v6
v_lshrrev_b32 v4, 1, v4
v_cmp_eq_u32 s[4:5], 0, v4
v_cmp_eq_u32 s[6:7], 1, v4
v_cmp_eq_u32 s[8:9], 2, v4
v_cmp_eq_u32 s[10:11], 3, v4
v_cndmask_b32 v248, 0, v5, s[4:5]
v_cndmask_b32 v249, 0, v5, s[6:7]
v_cndmask_b32 v250, 0, v5, s[8:9]
v_cndmask_b32 v251, 0, v5, s[10:11]
v_lshl_add_u32 v4, v9, 4, v8
v_and_b32 v5, 1, v4
v_lshlrev_b32 v5, 4, v5
v_lshlrev_b32 v5, v5, v6
v_lshrrev_b32 v4, 1, v4
v_cmp_eq_u32 s[4:5], 0, v4
v_cmp_eq_u32 s[6:7], 1, v4
v_cmp_eq_u32 s[8:9], 2, v4
v_cmp_eq_u32 s[10:11], 3, v4
v_cndmask_b32 v36, 0, v5, s[4:5]
v_cndmask_b32 v37, 0, v5, s[6:7]
v_cndmask_b32 v38, 0, v5, s[8:9]
v_cndmask_b32 v39, 0, v5, s[10:11]
s_and_b32 s57, s56, 3
s_lshl_b32 s98, s56, 5
s_lshl_b32 s29, s101, 1
s_add_u32 s98, s98, s29
s_lshl_b32 s27, s52, 8
s_lshl_b32 s26, s98, 13
s_add_u32 s26, s26, s27
v_lshlrev_b32 v4, 11, v11
v_lshl_add_u32 v4, v12, 4, v4
s_sub_u32 s40, s98, 16
s_cmp_eq_u32 s57, 0
s_cselect_b32 s40, s98, s40
s_add_u32 s41, s98, 32
s_cmp_eq_u32 s57, 3
s_cselect_b32 s41, s98, s41
v_mov_b32 v8, s40
v_mov_b32 v9, s41
v_cmp_le_u32 vcc, 8, v12
s_lshr_b32 s46, s98, 1
s_lshl_b32 s46, s46, 7
s_add_u32 s46, s46, 6422528
s_lshr_b32 s48, s40, 1
s_lshl_b32 s48, s48, 7
s_add_u32 s48, s48, 6422528
s_lshr_b32 s49, s41, 1
s_lshl_b32 s49, s49, 7
s_add_u32 s49, s49, 6422528
s_add_u32 s47, s46, 1024
s_mov_b32 s64, s59
s_mov_b32 s65, s59
v_and_b32 v24, 1, v1
v_and_b32 v25, 2, v1
v_lshl_add_u32 v24, v25, 6, v24
v_add_u32 v24, 125, v24
v_bfe_u32 v25, v1, 3, 2
v_and_b32 v26, 7, v1
v_lshl_add_u32 v25, v25, 6, v26
s_lshr_b32 s42, s2, 5
s_lshl_b32 s42, s42, 3
v_add_u32 v25, s42, v25
v_cmp_le_u32 s[6:7], 2, v11
s_lshl_b32 s32, s2, 7
s_add_u32 s32, s32, 6553600
v_cndmask_b32 v5, v24, v25, s[6:7]
v_lshlrev_b32 v5, 7, v5
s_mov_b32 s28, 6553600
v_cndmask_b32 v254, v8, v9, vcc
v_lshlrev_b32 v254, 13, v254
v_lshl_add_u32 v254, v11, 11, v254
v_bfe_u32 v8, v12, 1, 1
v_lshl_add_u32 v254, v8, 10, v254
v_bfe_u32 v8, v12, 2, 1
v_add_u32 v9, 14, v8
v_cndmask_b32 v8, v9, v8, vcc
v_lshl_add_u32 v254, v8, 4, v254
v_and_b32 v8, 1, v12
v_lshl_add_u32 v254, v8, 3, v254
s_add_u32 s33, s27, 8192
s_lshl_b32 s29, s52, 3
s_add_u32 s29, s29, 131072
v_and_b32 v8, 7, v12
v_add_u32 v9, 135, v8
v_subrev_u32 v8, 1, v8
v_cndmask_b32 v8, v8, v9, vcc
v_min_u32 v8, 143, v8
v_lshrrev_b32 v9, 3, v8
v_mul_u32_u24 v255, 576, v9
v_and_b32 v9, 7, v8
v_lshl_add_u32 v255, v9, 6, v255
v_and_b32 v9, 32, v8
v_add3_u32 v255, v255, v9, s29
v_lshl_add_u32 v255, v11, 1, v255
v_lshl_add_u32 v8, v12, 2, v11
v_add_u32 v10, 7, v8
v_lshrrev_b32 v9, 3, v10
v_mul_u32_u24 v6, 576, v9
v_and_b32 v9, 7, v10
v_lshl_add_u32 v6, v9, 6, v6
v_and_b32 v9, 32, v10
v_add3_u32 v6, v6, v9, s29
v_xor_b32 v7, 32, v6
v_xor_b32 v10, 32, v255
s_mov_b32 s50, 0x00ff00ff
s_cmp_lg_u32 s57, 0
s_cselect_b32 s50, s50, 0
s_mov_b32 s51, 0xff00ff00
s_cmp_lg_u32 s57, 3
s_cselect_b32 s51, s51, 0
s_cselect_b32 s60, 64, 52
s_or_b32 s50, s50, s51
s_mov_b32 s51, s50
v_cmp_gt_u32 s[38:39], s60, v8
v_bfe_u32 v13, v1, 2, 2
v_and_b32 v9, 1, v11
v_lshl_or_b32 v24, v9, 2, v13
v_lshl_add_u32 v25, v11, 3, v13
v_lshlrev_b32 v25, 9, v25
v_and_b32 v8, 3, v1
v_lshl_add_u32 v25, v8, 3, v25
s_lshl_b32 s29, s52, 2
s_add_u32 s60, s29, 0
v_xor_b32 v8, s60, v24
v_lshl_add_u32 v228, v8, 5, v25
v_add_u32 v229, 0x10000, v228
s_add_u32 s60, s29, 1
v_xor_b32 v8, s60, v24
v_lshl_add_u32 v230, v8, 5, v25
v_add_u32 v231, 0x10000, v230
s_add_u32 s60, s29, 2
v_xor_b32 v8, s60, v24
v_lshl_add_u32 v232, v8, 5, v25
v_add_u32 v233, 0x10000, v232
s_add_u32 s60, s29, 3
v_xor_b32 v8, s60, v24
v_lshl_add_u32 v234, v8, 5, v25
v_add_u32 v235, 0x10000, v234
v_mov_b32 v130, 0
v_mov_b32 v131, 0
v_mov_b32 v134, 0
v_mov_b32 v135, 0
s_add_u32 s20, s26, 8192
s_add_u32 s21, s26, 131072
s_add_u32 s22, s26, 139264
v_mov_b32 v28, -1
v_mov_b32 v29, -1
v_mov_b32 v30, -1
v_mov_b32 v31, -1
s_and_b32 s60, s2, 127
s_sub_u32 s60, s60, 125
s_cmp_ge_u32 s60, 2
s_cbranch_scc1 L_nogp
s_lshr_b32 s61, s2, 7
s_lshl_b32 s61, s61, 1
s_add_u32 s60, s60, s61
s_lshl_b32 s60, s60, 11
s_lshr_b32 s61, s52, 1
s_lshl_b32 s61, s61, 13
s_add_u32 s60, s60, s61
s_and_b32 s61, s52, 1
s_lshl_b32 s61, s61, 10
s_add_u32 s60, s60, s61
s_add_u32 s60, s60, 6291456
buffer_store_dwordx4 v[28:31], v2, s[12:15], s60 offen sc1
L_nogp:
s_cmp_eq_u32 s3, 1
s_cbranch_scc1 L_w2a
s_mov_b32 s61, 1048576
LL4:
ds_read_b32 v13, v236 offset:12
s_sub_u32 s61, s61, 1
s_cbranch_scc1 LLX4
s_waitcnt lgkmcnt(0)
v_cmp_ne_u32 vcc, 4, v13
s_cbranch_vccnz LL4
LLX4:
ds_read_b64_tr_b16 v[160:161], v14 offset:0
ds_read_b64_tr_b16 v[162:163], v14 offset:512
ds_read_b64_tr_b16 v[164:165], v14 offset:4096
ds_read_b64_tr_b16 v[166:167], v14 offset:4608
ds_read_b64_tr_b16 v[168:169], v14 offset:8192
ds_read_b64_tr_b16 v[170:171], v14 offset:8704
ds_read_b64_tr_b16 v[172:173], v14 offset:12288
ds_read_b64_tr_b16 v[174:175], v14 offset:12800
ds_read_b64_tr_b16 v[176:177], v14 offset:16384
ds_read_b64_tr_b16 v[178:179], v14 offset:16896
ds_read_b64_tr_b16 v[180:181], v14 offset:20480
ds_read_b64_tr_b16 v[182:183], v14 offset:20992
ds_read_b64_tr_b16 v[184:185], v14 offset:24576
ds_read_b64_tr_b16 v[186:187], v14 offset:25088
ds_read_b64_tr_b16 v[188:189], v14 offset:28672
ds_read_b64_tr_b16 v[190:191], v14 offset:29184
ds_read_b64_tr_b16 v[192:193], v14 offset:32768
ds_read_b64_tr_b16 v[194:195], v14 offset:33280
ds_read_b64_tr_b16 v[196:197], v14 offset:36864
ds_read_b64_tr_b16 v[198:199], v14 offset:37376
ds_read_b64_tr_b16 v[200:201], v14 offset:40960
ds_read_b64_tr_b16 v[202:203], v14 offset:41472
ds_read_b64_tr_b16 v[204:205], v14 offset:45056
ds_read_b64_tr_b16 v[206:207], v14 offset:45568
ds_read_b64_tr_b16 v[208:209], v14 offset:49152
ds_read_b64_tr_b16 v[210:211], v14 offset:49664
ds_read_b64_tr_b16 v[212:213], v14 offset:53248
ds_read_b64_tr_b16 v[214:215], v14 offset:53760
ds_read_b64_tr_b16 v[216:217], v14 offset:57344
ds_read_b64_tr_b16 v[218:219], v14 offset:57856
L_w2a:
s_cmp_lg_u32 s3, 1
s_cbranch_scc1 LWP1
s_mov_b32 s61, 262144
LS5:
s_load_dwordx8 s[4:11], s[12:13], s46 glc
s_load_dwordx8 s[72:79], s[12:13], s47 glc
s_load_dwordx8 s[80:87], s[12:13], s48 glc
s_load_dwordx8 s[88:95], s[12:13], s49 glc
s_sub_u32 s61, s61, 1
s_cbranch_scc1 LSX5
s_waitcnt lgkmcnt(0)
s_xor_b64 s[4:5], s[4:5], s[64:65]
s_xor_b64 s[6:7], s[6:7], s[64:65]
s_xor_b64 s[8:9], s[8:9], s[64:65]
s_xor_b64 s[10:11], s[10:11], s[64:65]
s_xor_b64 s[72:73], s[72:73], s[64:65]
s_xor_b64 s[74:75], s[74:75], s[64:65]
s_xor_b64 s[76:77], s[76:77], s[64:65]
s_xor_b64 s[78:79], s[78:79], s[64:65]
s_xor_b64 s[80:81], s[80:81], s[64:65]
s_xor_b64 s[82:83], s[82:83], s[64:65]
s_xor_b64 s[84:85], s[84:85], s[64:65]
s_xor_b64 s[86:87], s[86:87], s[64:65]
s_xor_b64 s[88:89], s[88:89], s[64:65]
s_xor_b64 s[90:91], s[90:91], s[64:65]
s_xor_b64 s[92:93], s[92:93], s[64:65]
s_xor_b64 s[94:95], s[94:95], s[64:65]
s_or_b64 s[4:5], s[4:5], s[6:7]
s_or_b64 s[4:5], s[4:5], s[8:9]
s_or_b64 s[4:5], s[4:5], s[10:11]
s_or_b64 s[4:5], s[4:5], s[72:73]
s_or_b64 s[4:5], s[4:5], s[74:75]
s_or_b64 s[4:5], s[4:5], s[76:77]
s_or_b64 s[4:5], s[4:5], s[78:79]
s_or_b64 s[4:5], s[4:5], s[80:81]
s_or_b64 s[4:5], s[4:5], s[82:83]
s_or_b64 s[4:5], s[4:5], s[84:85]
s_or_b64 s[4:5], s[4:5], s[86:87]
s_or_b64 s[4:5], s[4:5], s[88:89]
s_or_b64 s[4:5], s[4:5], s[90:91]
s_or_b64 s[4:5], s[4:5], s[92:93]
s_or_b64 s[4:5], s[4:5], s[94:95]
s_cbranch_scc1 LS5
LSX5:
ds_write_b32 v236, v237 offset:20
s_branch LWQ1
LWP1:
s_mov_b32 s61, 1048576
LL6:
ds_read_b32 v13, v236 offset:20
s_sub_u32 s61, s61, 1
s_cbranch_scc1 LLX6
s_waitcnt lgkmcnt(0)
v_cmp_ne_u32 vcc, 1, v13
s_cbranch_vccnz LL6
LLX6:
LWQ1:
s_waitcnt vmcnt(0)
buffer_load_dwordx4 v[96:99], v4, s[12:15], s26 offen sc1
buffer_load_dwordx4 v[100:103], v4, s[12:15], s26 offen offset:1024 sc1
buffer_load_dwordx4 v[104:107], v4, s[12:15], s20 offen sc1
buffer_load_dwordx4 v[108:111], v4, s[12:15], s20 offen offset:1024 sc1
buffer_load_dwordx4 v[112:115], v4, s[12:15], s21 offen sc1
buffer_load_dwordx4 v[116:119], v4, s[12:15], s21 offen offset:1024 sc1
buffer_load_dwordx4 v[120:123], v4, s[12:15], s22 offen sc1
buffer_load_dwordx4 v[124:127], v4, s[12:15], s22 offen offset:1024 sc1
buffer_load_dwordx2 v[128:129], v254, s[12:15], s27 offen sc1
buffer_load_dwordx2 v[132:133], v254, s[12:15], s33 offen sc1
s_cmp_lg_u32 s3, 1
s_cbranch_scc1 L_w2b
s_mov_b32 s61, 1048576
LL7:
ds_read_b32 v13, v236 offset:12
s_sub_u32 s61, s61, 1
s_cbranch_scc1 LLX7
s_waitcnt lgkmcnt(0)
v_cmp_ne_u32 vcc, 4, v13
s_cbranch_vccnz LL7
LLX7:
ds_read_b64_tr_b16 v[160:161], v14 offset:0
ds_read_b64_tr_b16 v[162:163], v14 offset:512
ds_read_b64_tr_b16 v[164:165], v14 offset:4096
ds_read_b64_tr_b16 v[166:167], v14 offset:4608
ds_read_b64_tr_b16 v[168:169], v14 offset:8192
ds_read_b64_tr_b16 v[170:171], v14 offset:8704
ds_read_b64_tr_b16 v[172:173], v14 offset:12288
ds_read_b64_tr_b16 v[174:175], v14 offset:12800
ds_read_b64_tr_b16 v[176:177], v14 offset:16384
ds_read_b64_tr_b16 v[178:179], v14 offset:16896
ds_read_b64_tr_b16 v[180:181], v14 offset:20480
ds_read_b64_tr_b16 v[182:183], v14 offset:20992
ds_read_b64_tr_b16 v[184:185], v14 offset:24576
ds_read_b64_tr_b16 v[186:187], v14 offset:25088
ds_read_b64_tr_b16 v[188:189], v14 offset:28672
ds_read_b64_tr_b16 v[190:191], v14 offset:29184
ds_read_b64_tr_b16 v[192:193], v14 offset:32768
ds_read_b64_tr_b16 v[194:195], v14 offset:33280
ds_read_b64_tr_b16 v[196:197], v14 offset:36864
ds_read_b64_tr_b16 v[198:199], v14 offset:37376
ds_read_b64_tr_b16 v[200:201], v14 offset:40960
ds_read_b64_tr_b16 v[202:203], v14 offset:41472
ds_read_b64_tr_b16 v[204:205], v14 offset:45056
ds_read_b64_tr_b16 v[206:207], v14 offset:45568
ds_read_b64_tr_b16 v[208:209], v14 offset:49152
ds_read_b64_tr_b16 v[210:211], v14 offset:49664
ds_read_b64_tr_b16 v[212:213], v14 offset:53248
ds_read_b64_tr_b16 v[214:215], v14 offset:53760
ds_read_b64_tr_b16 v[216:217], v14 offset:57344
ds_read_b64_tr_b16 v[218:219], v14 offset:57856
L_w2b:
s_mov_b64 exec, 1
ds_add_rtn_u32 v13, v236, v237 offset:8
s_mov_b64 exec, -1
s_waitcnt lgkmcnt(0)
v_readfirstlane_b32 s61, v13
s_cmp_lg_u32 s61, 3
s_cbranch_scc1 LWF3
s_atomic_swap s59, s[12:13], s32
LWF3:
s_waitcnt vmcnt(6)
v_mfma_f32_16x16x32_bf16 v[40:43], v[240:243], v[96:99], 0
v_mfma_f32_16x16x32_bf16 v[44:47], v[240:243], v[104:107], 0
v_mfma_f32_16x16x32_bf16 v[40:43], v[244:247], v[100:103], v[40:43]
v_mfma_f32_16x16x32_bf16 v[44:47], v[244:247], v[108:111], v[44:47]
s_nop 7
v_pk_mul_f32 v[64:65], v[40:41], v[40:41]
v_pk_mul_f32 v[66:67], v[42:43], v[42:43]
v_pk_mul_f32 v[68:69], v[44:45], v[44:45]
v_pk_mul_f32 v[70:71], v[46:47], v[46:47]
v_pk_fma_f32 v[64:65], v[64:65], s[66:67], v[252:253]
v_pk_fma_f32 v[66:67], v[66:67], s[66:67], v[252:253]
v_pk_fma_f32 v[68:69], v[68:69], s[66:67], v[252:253]
v_pk_fma_f32 v[70:71], v[70:71], s[66:67], v[252:253]
v_pk_mul_f32 v[64:65], v[64:65], v[40:41]
v_pk_mul_f32 v[66:67], v[66:67], v[42:43]
v_pk_mul_f32 v[68:69], v[68:69], v[44:45]
v_pk_mul_f32 v[70:71], v[70:71], v[46:47]
v_exp_f32 v64, v64
v_exp_f32 v65, v65
v_exp_f32 v66, v66
v_exp_f32 v67, v67
v_exp_f32 v68, v68
v_exp_f32 v69, v69
v_exp_f32 v70, v70
v_exp_f32 v71, v71
v_pk_add_f32 v[64:65], v[64:65], 1.0 op_sel_hi:[1,0]
v_pk_add_f32 v[66:67], v[66:67], 1.0 op_sel_hi:[1,0]
v_pk_add_f32 v[68:69], v[68:69], 1.0 op_sel_hi:[1,0]
v_pk_add_f32 v[70:71], v[70:71], 1.0 op_sel_hi:[1,0]
v_rcp_f32 v64, v64
v_rcp_f32 v65, v65
v_rcp_f32 v66, v66
v_rcp_f32 v67, v67
v_rcp_f32 v68, v68
v_rcp_f32 v69, v69
v_rcp_f32 v70, v70
v_rcp_f32 v71, v71
v_pk_mul_f32 v[40:41], v[40:41], v[64:65]
v_pk_mul_f32 v[42:43], v[42:43], v[66:67]
v_pk_mul_f32 v[44:45], v[44:45], v[68:69]
v_pk_mul_f32 v[46:47], v[46:47], v[70:71]
v_cvt_pk_bf16_f32 v40, v40, v41
v_cvt_pk_bf16_f32 v41, v42, v43
ds_write_b64 v6, v[40:41] offset:0
v_cvt_pk_bf16_f32 v44, v44, v45
v_cvt_pk_bf16_f32 v45, v46, v47
ds_write_b64 v7, v[44:45] offset:0
s_waitcnt vmcnt(0)
v_mfma_f32_16x16x32_bf16 v[48:51], v[240:243], v[112:115], 0
v_mfma_f32_16x16x32_bf16 v[52:55], v[240:243], v[120:123], 0
v_mfma_f32_16x16x32_bf16 v[48:51], v[244:247], v[116:119], v[48:51]
v_mfma_f32_16x16x32_bf16 v[52:55], v[244:247], v[124:127], v[52:55]
v_mfma_f32_16x16x32_bf16 v[56:59], v[36:39], v[128:131], 0
v_mfma_f32_16x16x32_bf16 v[60:63], v[36:39], v[132:135], 0
s_nop 7
v_mov_b32 v57, v60
v_pk_mul_f32 v[64:65], v[48:49], v[48:49]
v_pk_mul_f32 v[66:67], v[50:51], v[50:51]
v_pk_mul_f32 v[68:69], v[52:53], v[52:53]
v_pk_mul_f32 v[70:71], v[54:55], v[54:55]
v_pk_mul_f32 v[72:73], v[56:57], v[56:57]
v_pk_fma_f32 v[64:65], v[64:65], s[66:67], v[252:253]
v_pk_fma_f32 v[66:67], v[66:67], s[66:67], v[252:253]
v_pk_fma_f32 v[68:69], v[68:69], s[66:67], v[252:253]
v_pk_fma_f32 v[70:71], v[70:71], s[66:67], v[252:253]
v_pk_fma_f32 v[72:73], v[72:73], s[66:67], v[252:253]
v_pk_mul_f32 v[64:65], v[64:65], v[48:49]
v_pk_mul_f32 v[66:67], v[66:67], v[50:51]
v_pk_mul_f32 v[68:69], v[68:69], v[52:53]
v_pk_mul_f32 v[70:71], v[70:71], v[54:55]
v_pk_mul_f32 v[72:73], v[72:73], v[56:57]
v_exp_f32 v64, v64
v_exp_f32 v65, v65
v_exp_f32 v66, v66
v_exp_f32 v67, v67
v_exp_f32 v68, v68
v_exp_f32 v69, v69
v_exp_f32 v70, v70
v_exp_f32 v71, v71
v_exp_f32 v72, v72
v_exp_f32 v73, v73
v_pk_add_f32 v[64:65], v[64:65], 1.0 op_sel_hi:[1,0]
v_pk_add_f32 v[66:67], v[66:67], 1.0 op_sel_hi:[1,0]
v_pk_add_f32 v[68:69], v[68:69], 1.0 op_sel_hi:[1,0]
v_pk_add_f32 v[70:71], v[70:71], 1.0 op_sel_hi:[1,0]
v_pk_add_f32 v[72:73], v[72:73], 1.0 op_sel_hi:[1,0]
v_rcp_f32 v64, v64
v_rcp_f32 v65, v65
v_rcp_f32 v66, v66
v_rcp_f32 v67, v67
v_rcp_f32 v68, v68
v_rcp_f32 v69, v69
v_rcp_f32 v70, v70
v_rcp_f32 v71, v71
v_rcp_f32 v72, v72
v_rcp_f32 v73, v73
v_pk_mul_f32 v[48:49], v[48:49], v[64:65]
v_pk_mul_f32 v[50:51], v[50:51], v[66:67]
v_pk_mul_f32 v[52:53], v[52:53], v[68:69]
v_pk_mul_f32 v[54:55], v[54:55], v[70:71]
v_pk_mul_f32 v[56:57], v[56:57], v[72:73]
v_cvt_pk_bf16_f32 v48, v48, v49
v_cvt_pk_bf16_f32 v49, v50, v51
v_cndmask_b32 v48, 0, v48, s[38:39]
v_cndmask_b32 v49, 0, v49, s[38:39]
ds_write_b64 v6, v[48:49] offset:4608
v_cvt_pk_bf16_f32 v52, v52, v53
v_cvt_pk_bf16_f32 v53, v54, v55
v_cndmask_b32 v52, 0, v52, s[38:39]
v_cndmask_b32 v53, 0, v53, s[38:39]
ds_write_b64 v7, v[52:53] offset:4608
v_cvt_pk_bf16_f32 v56, v56, v57
v_cndmask_b32 v56, 0, v56, s[50:51]
ds_write_b16 v255, v56
ds_write_b16_d16_hi v10, v56
s_waitcnt lgkmcnt(0)
s_and_b32 s60, s2, 127
s_cmp_ge_u32 s60, 125
s_cbranch_scc1 L_hbl
s_barrier
s_branch L_hbd
L_hbl:
s_mov_b64 exec, 1
ds_add_u32 v236, v237 offset:4
s_mov_b64 exec, -1
s_mov_b32 s61, 1048576
LL8:
ds_read_b32 v13, v236 offset:4
s_sub_u32 s61, s61, 1
s_cbranch_scc1 LLX8
s_waitcnt lgkmcnt(0)
v_cmp_ne_u32 vcc, 4, v13
s_cbranch_vccnz LL8
LLX8:
L_hbd:
ds_read_b128 v[40:43], v224 offset:0
ds_read_b128 v[44:47], v224 offset:128
ds_read_b128 v[48:51], v224 offset:256
ds_read_b128 v[52:55], v224 offset:384
ds_read_b128 v[56:59], v225 offset:0
s_waitcnt lgkmcnt(1)
v_mfma_f32_16x16x32_bf16 v[20:23], v[160:163], v[40:43], 0
ds_read_b128 v[60:63], v225 offset:128
v_mfma_f32_16x16x32_bf16 v[24:27], v[160:163], v[44:47], 0
v_mfma_f32_16x16x32_bf16 v[28:31], v[160:163], v[48:51], 0
v_mfma_f32_16x16x32_bf16 v[32:35], v[160:163], v[52:55], 0
s_waitcnt lgkmcnt(1)
v_mfma_f32_16x16x32_bf16 v[20:23], v[164:167], v[44:47], v[20:23]
ds_read_b128 v[40:43], v225 offset:256
v_mfma_f32_16x16x32_bf16 v[24:27], v[164:167], v[48:51], v[24:27]
v_mfma_f32_16x16x32_bf16 v[28:31], v[164:167], v[52:55], v[28:31]
v_mfma_f32_16x16x32_bf16 v[32:35], v[164:167], v[56:59], v[32:35]
s_waitcnt lgkmcnt(1)
v_mfma_f32_16x16x32_bf16 v[20:23], v[168:171], v[48:51], v[20:23]
ds_read_b128 v[44:47], v225 offset:384
v_mfma_f32_16x16x32_bf16 v[24:27], v[168:171], v[52:55], v[24:27]
v_mfma_f32_16x16x32_bf16 v[28:31], v[168:171], v[56:59], v[28:31]
v_mfma_f32_16x16x32_bf16 v[32:35], v[168:171], v[60:63], v[32:35]
s_waitcnt lgkmcnt(1)
v_mfma_f32_16x16x32_bf16 v[20:23], v[172:175], v[52:55], v[20:23]
ds_read_b128 v[48:51], v226 offset:0
v_mfma_f32_16x16x32_bf16 v[24:27], v[172:175], v[56:59], v[24:27]
v_mfma_f32_16x16x32_bf16 v[28:31], v[172:175], v[60:63], v[28:31]
v_mfma_f32_16x16x32_bf16 v[32:35], v[172:175], v[40:43], v[32:35]
s_waitcnt lgkmcnt(1)
v_mfma_f32_16x16x32_bf16 v[20:23], v[176:179], v[56:59], v[20:23]
ds_read_b128 v[52:55], v226 offset:128
v_mfma_f32_16x16x32_bf16 v[24:27], v[176:179], v[60:63], v[24:27]
v_mfma_f32_16x16x32_bf16 v[28:31], v[176:179], v[40:43], v[28:31]
v_mfma_f32_16x16x32_bf16 v[32:35], v[176:179], v[44:47], v[32:35]
s_waitcnt lgkmcnt(1)
v_mfma_f32_16x16x32_bf16 v[20:23], v[180:183], v[60:63], v[20:23]
ds_read_b128 v[56:59], v226 offset:256
v_mfma_f32_16x16x32_bf16 v[24:27], v[180:183], v[40:43], v[24:27]
v_mfma_f32_16x16x32_bf16 v[28:31], v[180:183], v[44:47], v[28:31]
v_mfma_f32_16x16x32_bf16 v[32:35], v[180:183], v[48:51], v[32:35]
s_waitcnt lgkmcnt(1)
v_mfma_f32_16x16x32_bf16 v[20:23], v[184:187], v[40:43], v[20:23]
ds_read_b128 v[96:99], v224 offset:64
v_mfma_f32_16x16x32_bf16 v[24:27], v[184:187], v[44:47], v[24:27]
ds_read_b128 v[100:103], v224 offset:192
v_mfma_f32_16x16x32_bf16 v[28:31], v[184:187], v[48:51], v[28:31]
ds_read_b128 v[104:107], v224 offset:320
v_mfma_f32_16x16x32_bf16 v[32:35], v[184:187], v[52:55], v[32:35]
ds_read_b128 v[108:111], v224 offset:448
s_waitcnt lgkmcnt(4)
v_mfma_f32_16x16x32_bf16 v[20:23], v[188:191], v[44:47], v[20:23]
ds_read_b128 v[112:115], v225 offset:64
v_mfma_f32_16x16x32_bf16 v[24:27], v[188:191], v[48:51], v[24:27]
v_mfma_f32_16x16x32_bf16 v[28:31], v[188:191], v[52:55], v[28:31]
v_mfma_f32_16x16x32_bf16 v[32:35], v[188:191], v[56:59], v[32:35]
s_waitcnt lgkmcnt(1)
v_mfma_f32_16x16x32_bf16 v[20:23], v[192:195], v[96:99], v[20:23]
ds_read_b128 v[116:119], v225 offset:192
v_mfma_f32_16x16x32_bf16 v[24:27], v[192:195], v[100:103], v[24:27]
v_mfma_f32_16x16x32_bf16 v[28:31], v[192:195], v[104:107], v[28:31]
v_mfma_f32_16x16x32_bf16 v[32:35], v[192:195], v[108:111], v[32:35]
s_waitcnt lgkmcnt(1)
v_mfma_f32_16x16x32_bf16 v[20:23], v[196:199], v[100:103], v[20:23]
ds_read_b128 v[96:99], v225 offset:320
v_mfma_f32_16x16x32_bf16 v[24:27], v[196:199], v[104:107], v[24:27]
v_mfma_f32_16x16x32_bf16 v[28:31], v[196:199], v[108:111], v[28:31]
v_mfma_f32_16x16x32_bf16 v[32:35], v[196:199], v[112:115], v[32:35]
s_waitcnt lgkmcnt(1)
v_mfma_f32_16x16x32_bf16 v[20:23], v[200:203], v[104:107], v[20:23]
ds_read_b128 v[100:103], v225 offset:448
v_mfma_f32_16x16x32_bf16 v[24:27], v[200:203], v[108:111], v[24:27]
v_mfma_f32_16x16x32_bf16 v[28:31], v[200:203], v[112:115], v[28:31]
v_mfma_f32_16x16x32_bf16 v[32:35], v[200:203], v[116:119], v[32:35]
s_waitcnt lgkmcnt(1)
v_mfma_f32_16x16x32_bf16 v[20:23], v[204:207], v[108:111], v[20:23]
ds_read_b128 v[104:107], v226 offset:64
v_mfma_f32_16x16x32_bf16 v[24:27], v[204:207], v[112:115], v[24:27]
v_mfma_f32_16x16x32_bf16 v[28:31], v[204:207], v[116:119], v[28:31]
v_mfma_f32_16x16x32_bf16 v[32:35], v[204:207], v[96:99], v[32:35]
s_waitcnt lgkmcnt(1)
v_mfma_f32_16x16x32_bf16 v[20:23], v[208:211], v[112:115], v[20:23]
ds_read_b128 v[108:111], v226 offset:192
v_mfma_f32_16x16x32_bf16 v[24:27], v[208:211], v[116:119], v[24:27]
v_mfma_f32_16x16x32_bf16 v[28:31], v[208:211], v[96:99], v[28:31]
v_mfma_f32_16x16x32_bf16 v[32:35], v[208:211], v[100:103], v[32:35]
s_waitcnt lgkmcnt(1)
v_mfma_f32_16x16x32_bf16 v[20:23], v[212:215], v[116:119], v[20:23]
v_mfma_f32_16x16x32_bf16 v[24:27], v[212:215], v[96:99], v[24:27]
v_mfma_f32_16x16x32_bf16 v[28:31], v[212:215], v[100:103], v[28:31]
v_mfma_f32_16x16x32_bf16 v[32:35], v[212:215], v[104:107], v[32:35]
buffer_load_dword v8, v5, s[12:15], s28 offen sc1
s_waitcnt lgkmcnt(0)
v_mfma_f32_16x16x32_bf16 v[20:23], v[216:219], v[96:99], v[20:23]
v_mfma_f32_16x16x32_bf16 v[24:27], v[216:219], v[100:103], v[24:27]
v_mfma_f32_16x16x32_bf16 v[28:31], v[216:219], v[104:107], v[28:31]
v_mfma_f32_16x16x32_bf16 v[32:35], v[216:219], v[108:111], v[32:35]
s_nop 4
v_cvt_pk_bf16_f32 v40, v20, v21
v_cvt_pk_bf16_f32 v41, v22, v23
v_min_u32 v40, -2, v40
v_min_u32 v41, -2, v41
v_cvt_pk_bf16_f32 v42, v24, v25
v_cvt_pk_bf16_f32 v43, v26, v27
v_min_u32 v42, -2, v42
v_min_u32 v43, -2, v43
buffer_store_dwordx4 v[40:43], v3, s[12:15], s24 offen offset:0 sc1
v_cvt_pk_bf16_f32 v44, v28, v29
v_cvt_pk_bf16_f32 v45, v30, v31
v_min_u32 v44, -2, v44
v_min_u32 v45, -2, v45
v_cvt_pk_bf16_f32 v46, v32, v33
v_cvt_pk_bf16_f32 v47, v34, v35
v_min_u32 v46, -2, v46
v_min_u32 v47, -2, v47
buffer_store_dwordx4 v[44:47], v3, s[12:15], s25 offen offset:0 sc1
s_lshr_b32 s57, s2, 7
s_and_b32 s58, s2, 127
s_lshl_b32 s21, s57, 13
s_lshl_b32 s29, s52, 11
s_add_u32 s21, s21, s29
s_add_u32 s21, s21, 6291456
v_lshlrev_b32 v4, 10, v11
v_lshl_add_u32 v4, v12, 4, v4
s_lshl_b32 s26, s2, 13
s_add_u32 s26, s26, s27
s_add_u32 s26, s26, 2097152
s_add_u32 s20, s26, 4096
v_lshrrev_b32 v9, 1, v11
v_lshlrev_b32 v6, 9, v9
v_lshl_add_u32 v6, v12, 3, v6
v_and_b32 v9, 1, v11
v_lshl_add_u32 v6, v9, 2, v6
s_lshl_b32 s29, s52, 7
s_add_u32 s29, s29, 142464
v_add_u32 v6, s29, v6
v_lshrrev_b32 v9, 3, v12
v_lshlrev_b32 v7, 9, v9
v_lshl_add_u32 v7, v11, 4, v7
v_add_u32 v7, 142464, v7
s_lshl_b32 s29, s52, 11
s_add_u32 s29, s29, 143488
v_add_u32 v10, s29, v2
v_and_b32 v9, 7, v12
v_lshlrev_b32 v9, 4, v9
v_lshl_add_u32 v9, v11, 7, v9
s_cmp_ge_u32 s58, 125
s_cbranch_scc1 L_main_idle
s_waitcnt vmcnt(2)
v_cmp_ne_u32 vcc, s59, v8
s_cbranch_vccz L_f2ok
s_mov_b32 s61, 262144
LP9:
buffer_load_dword v8, v5, s[12:15], s28 offen sc1
s_sub_u32 s61, s61, 1
s_cbranch_scc1 LPX9
s_waitcnt vmcnt(0)
v_cmp_ne_u32 vcc, s59, v8
s_cbranch_vccnz LP9
LPX9:
L_f2ok:
s_mov_b32 s61, 1048576
LL10:
ds_read_b32 v13, v236 offset:32
s_sub_u32 s61, s61, 1
s_cbranch_scc1 LLX10
s_waitcnt lgkmcnt(0)
v_cmp_ne_u32 vcc, 4, v13
s_cbranch_vccnz LL10
LLX10:
ds_read_b64_tr_b16 v[96:97], v228 offset:0
ds_read_b64_tr_b16 v[98:99], v228 offset:2048
ds_read_b64_tr_b16 v[100:101], v230 offset:0
ds_read_b64_tr_b16 v[102:103], v230 offset:2048
ds_read_b64_tr_b16 v[104:105], v232 offset:0
ds_read_b64_tr_b16 v[106:107], v232 offset:2048
ds_read_b64_tr_b16 v[108:109], v234 offset:0
ds_read_b64_tr_b16 v[110:111], v234 offset:2048
ds_read_b64_tr_b16 v[112:113], v228 offset:16384
ds_read_b64_tr_b16 v[114:115], v228 offset:18432
ds_read_b64_tr_b16 v[116:117], v230 offset:16384
ds_read_b64_tr_b16 v[118:119], v230 offset:18432
ds_read_b64_tr_b16 v[120:121], v232 offset:16384
ds_read_b64_tr_b16 v[122:123], v232 offset:18432
ds_read_b64_tr_b16 v[124:125], v234 offset:16384
ds_read_b64_tr_b16 v[126:127], v234 offset:18432
ds_read_b64_tr_b16 v[128:129], v228 offset:32768
ds_read_b64_tr_b16 v[130:131], v228 offset:34816
ds_read_b64_tr_b16 v[132:133], v230 offset:32768
ds_read_b64_tr_b16 v[134:135], v230 offset:34816
ds_read_b64_tr_b16 v[136:137], v232 offset:32768
ds_read_b64_tr_b16 v[138:139], v232 offset:34816
ds_read_b64_tr_b16 v[140:141], v234 offset:32768
ds_read_b64_tr_b16 v[142:143], v234 offset:34816
ds_read_b64_tr_b16 v[144:145], v228 offset:49152
ds_read_b64_tr_b16 v[146:147], v228 offset:51200
ds_read_b64_tr_b16 v[148:149], v230 offset:49152
ds_read_b64_tr_b16 v[150:151], v230 offset:51200
ds_read_b64_tr_b16 v[152:153], v232 offset:49152
ds_read_b64_tr_b16 v[154:155], v232 offset:51200
ds_read_b64_tr_b16 v[156:157], v234 offset:49152
ds_read_b64_tr_b16 v[158:159], v234 offset:51200
ds_read_b64_tr_b16 v[160:161], v229 offset:0
ds_read_b64_tr_b16 v[162:163], v229 offset:2048
ds_read_b64_tr_b16 v[164:165], v231 offset:0
ds_read_b64_tr_b16 v[166:167], v231 offset:2048
ds_read_b64_tr_b16 v[168:169], v233 offset:0
ds_read_b64_tr_b16 v[170:171], v233 offset:2048
ds_read_b64_tr_b16 v[172:173], v235 offset:0
ds_read_b64_tr_b16 v[174:175], v235 offset:2048
ds_read_b64_tr_b16 v[176:177], v229 offset:16384
ds_read_b64_tr_b16 v[178:179], v229 offset:18432
ds_read_b64_tr_b16 v[180:181], v231 offset:16384
ds_read_b64_tr_b16 v[182:183], v231 offset:18432
ds_read_b64_tr_b16 v[184:185], v233 offset:16384
ds_read_b64_tr_b16 v[186:187], v233 offset:18432
ds_read_b64_tr_b16 v[188:189], v235 offset:16384
ds_read_b64_tr_b16 v[190:191], v235 offset:18432
ds_read_b64_tr_b16 v[192:193], v229 offset:32768
ds_read_b64_tr_b16 v[194:195], v229 offset:34816
ds_read_b64_tr_b16 v[196:197], v231 offset:32768
ds_read_b64_tr_b16 v[198:199], v231 offset:34816
ds_read_b64_tr_b16 v[200:201], v233 offset:32768
ds_read_b64_tr_b16 v[202:203], v233 offset:34816
ds_read_b64_tr_b16 v[204:205], v235 offset:32768
ds_read_b64_tr_b16 v[206:207], v235 offset:34816
ds_read_b64_tr_b16 v[208:209], v229 offset:49152
ds_read_b64_tr_b16 v[210:211], v229 offset:51200
ds_read_b64_tr_b16 v[212:213], v231 offset:49152
ds_read_b64_tr_b16 v[214:215], v231 offset:51200
ds_read_b64_tr_b16 v[216:217], v233 offset:49152
ds_read_b64_tr_b16 v[218:219], v233 offset:51200
ds_read_b64_tr_b16 v[220:221], v235 offset:49152
ds_read_b64_tr_b16 v[222:223], v235 offset:51200
s_waitcnt vmcnt(0)
buffer_load_dwordx4 v[76:79], v4, s[12:15], s26 offen sc1
buffer_load_dwordx4 v[80:83], v4, s[12:15], s20 offen sc1
buffer_load_dwordx4 v[60:63], v9, s[12:15], s21 offen offset:0 sc1
buffer_load_dwordx4 v[64:67], v9, s[12:15], s21 offen offset:512 sc1
buffer_load_dwordx4 v[68:71], v9, s[12:15], s21 offen offset:1024 sc1
buffer_load_dwordx4 v[72:75], v9, s[12:15], s21 offen offset:1536 sc1
s_waitcnt vmcnt(4)
v_max3_u32 v13, v76, v77, v78
v_max3_u32 v13, v13, v79, v80
v_max3_u32 v13, v13, v81, v82
v_max_u32 v13, v13, v83
v_cmp_eq_u32 vcc, -1, v13
s_cbranch_vccz LVX11
s_mov_b32 s61, 262144
LV11:
buffer_load_dwordx4 v[76:79], v4, s[12:15], s26 offen sc1
buffer_load_dwordx4 v[80:83], v4, s[12:15], s20 offen sc1
s_sub_u32 s61, s61, 1
s_cbranch_scc1 LVX11
s_waitcnt vmcnt(0)
v_max3_u32 v13, v76, v77, v78
v_max3_u32 v13, v13, v79, v80
v_max3_u32 v13, v13, v81, v82
v_max_u32 v13, v13, v83
v_cmp_eq_u32 vcc, -1, v13
s_cbranch_vccnz LV11
LVX11:
v_mfma_f32_16x16x32_bf16 v[20:23], v[248:251], v[76:79], 0
v_mfma_f32_16x16x32_bf16 v[20:23], v[248:251], v[80:83], v[20:23]
s_nop 7
v_pk_mul_f32 v[22:23], v[20:21], v[20:21]
v_pk_fma_f32 v[22:23], v[22:23], s[66:67], v[252:253]
v_pk_mul_f32 v[22:23], v[22:23], v[20:21]
v_exp_f32 v22, v22
v_exp_f32 v23, v23
s_nop 0
v_pk_add_f32 v[22:23], v[22:23], 1.0 op_sel_hi:[1,0]
v_rcp_f32 v22, v22
v_rcp_f32 v23, v23
s_nop 0
v_pk_mul_f32 v[20:21], v[20:21], v[22:23]
v_cvt_pk_bf16_f32 v20, v20, v21
ds_write_b32 v6, v20
s_waitcnt vmcnt(0)
v_max3_u32 v13, v60, v61, v62
v_max3_u32 v13, v13, v63, v64
v_max3_u32 v13, v13, v65, v66
v_max3_u32 v13, v13, v67, v68
v_max3_u32 v13, v13, v69, v70
v_max3_u32 v13, v13, v71, v72
v_max3_u32 v13, v13, v73, v74
v_max_u32 v13, v13, v75
v_cmp_eq_u32 vcc, -1, v13
s_cbranch_vccz LVX12
s_mov_b32 s61, 262144
LV12:
buffer_load_dwordx4 v[60:63], v9, s[12:15], s21 offen offset:0 sc1
buffer_load_dwordx4 v[64:67], v9, s[12:15], s21 offen offset:512 sc1
buffer_load_dwordx4 v[68:71], v9, s[12:15], s21 offen offset:1024 sc1
buffer_load_dwordx4 v[72:75], v9, s[12:15], s21 offen offset:1536 sc1
s_sub_u32 s61, s61, 1
s_cbranch_scc1 LVX12
s_waitcnt vmcnt(0)
v_max3_u32 v13, v60, v61, v62
v_max3_u32 v13, v13, v63, v64
v_max3_u32 v13, v13, v65, v66
v_max3_u32 v13, v13, v67, v68
v_max3_u32 v13, v13, v69, v70
v_max3_u32 v13, v13, v71, v72
v_max3_u32 v13, v13, v73, v74
v_max_u32 v13, v13, v75
v_cmp_eq_u32 vcc, -1, v13
s_cbranch_vccnz LV12
LVX12:
s_waitcnt lgkmcnt(0)
s_barrier
ds_read_b128 v[24:27], v7 offset:0
ds_read_b128 v[28:31], v7 offset:64
ds_read_b128 v[32:35], v7 offset:128
ds_read_b128 v[36:39], v7 offset:192
ds_read_b128 v[40:43], v7 offset:256
ds_read_b128 v[44:47], v7 offset:320
ds_read_b128 v[48:51], v7 offset:384
ds_read_b128 v[52:55], v7 offset:448
v_mov_b32 v76, -2.0
v_mov_b32 v77, -2.0
s_waitcnt lgkmcnt(7)
v_mfma_f32_16x16x32_bf16 v[60:63], v[96:99], v[24:27], v[60:63]
v_mfma_f32_16x16x32_bf16 v[64:67], v[100:103], v[24:27], v[64:67]
s_waitcnt lgkmcnt(6)
v_mfma_f32_16x16x32_bf16 v[60:63], v[112:115], v[28:31], v[60:63]
v_mfma_f32_16x16x32_bf16 v[64:67], v[116:119], v[28:31], v[64:67]
s_waitcnt lgkmcnt(5)
v_mfma_f32_16x16x32_bf16 v[60:63], v[128:131], v[32:35], v[60:63]
v_mfma_f32_16x16x32_bf16 v[64:67], v[132:135], v[32:35], v[64:67]
s_waitcnt lgkmcnt(4)
v_mfma_f32_16x16x32_bf16 v[60:63], v[144:147], v[36:39], v[60:63]
v_mfma_f32_16x16x32_bf16 v[64:67], v[148:151], v[36:39], v[64:67]
s_waitcnt lgkmcnt(3)
v_mfma_f32_16x16x32_bf16 v[60:63], v[160:163], v[40:43], v[60:63]
v_mfma_f32_16x16x32_bf16 v[64:67], v[164:167], v[40:43], v[64:67]
s_waitcnt lgkmcnt(2)
v_mfma_f32_16x16x32_bf16 v[60:63], v[176:179], v[44:47], v[60:63]
v_mfma_f32_16x16x32_bf16 v[64:67], v[180:183], v[44:47], v[64:67]
s_waitcnt lgkmcnt(1)
v_mfma_f32_16x16x32_bf16 v[60:63], v[192:195], v[48:51], v[60:63]
v_mfma_f32_16x16x32_bf16 v[64:67], v[196:199], v[48:51], v[64:67]
s_waitcnt lgkmcnt(0)
v_mfma_f32_16x16x32_bf16 v[60:63], v[208:211], v[52:55], v[60:63]
v_mfma_f32_16x16x32_bf16 v[64:67], v[212:215], v[52:55], v[64:67]
v_mfma_f32_16x16x32_bf16 v[68:71], v[104:107], v[24:27], v[68:71]
v_mfma_f32_16x16x32_bf16 v[72:75], v[108:111], v[24:27], v[72:75]
v_mfma_f32_16x16x32_bf16 v[68:71], v[120:123], v[28:31], v[68:71]
v_mfma_f32_16x16x32_bf16 v[72:75], v[124:127], v[28:31], v[72:75]
v_mfma_f32_16x16x32_bf16 v[68:71], v[136:139], v[32:35], v[68:71]
v_mfma_f32_16x16x32_bf16 v[72:75], v[140:143], v[32:35], v[72:75]
v_mfma_f32_16x16x32_bf16 v[68:71], v[152:155], v[36:39], v[68:71]
v_mfma_f32_16x16x32_bf16 v[72:75], v[156:159], v[36:39], v[72:75]
v_mfma_f32_16x16x32_bf16 v[68:71], v[168:171], v[40:43], v[68:71]
v_pk_mul_f32 v[60:61], v[60:61], s[68:69]
v_pk_mul_f32 v[64:65], v[64:65], s[68:69]
v_pk_mul_f32 v[62:63], v[62:63], s[68:69]
v_pk_mul_f32 v[66:67], v[66:67], s[68:69]
v_mfma_f32_16x16x32_bf16 v[72:75], v[172:175], v[40:43], v[72:75]
v_exp_f32 v60, v60
v_exp_f32 v64, v64
v_exp_f32 v61, v61
v_exp_f32 v65, v65
v_mfma_f32_16x16x32_bf16 v[68:71], v[184:187], v[44:47], v[68:71]
v_exp_f32 v62, v62
v_exp_f32 v66, v66
v_exp_f32 v63, v63
v_exp_f32 v67, v67
v_mfma_f32_16x16x32_bf16 v[72:75], v[188:191], v[44:47], v[72:75]
v_pk_add_f32 v[60:61], v[60:61], 1.0 op_sel_hi:[1,0]
v_pk_add_f32 v[64:65], v[64:65], 1.0 op_sel_hi:[1,0]
v_pk_add_f32 v[62:63], v[62:63], 1.0 op_sel_hi:[1,0]
v_pk_add_f32 v[66:67], v[66:67], 1.0 op_sel_hi:[1,0]
v_mfma_f32_16x16x32_bf16 v[68:71], v[200:203], v[48:51], v[68:71]
v_rcp_f32 v60, v60
v_rcp_f32 v64, v64
v_rcp_f32 v61, v61
v_rcp_f32 v65, v65
v_mfma_f32_16x16x32_bf16 v[72:75], v[204:207], v[48:51], v[72:75]
v_rcp_f32 v62, v62
v_rcp_f32 v66, v66
v_rcp_f32 v63, v63
v_rcp_f32 v67, v67
v_mfma_f32_16x16x32_bf16 v[68:71], v[216:219], v[52:55], v[68:71]
v_pk_fma_f32 v[60:61], v[60:61], v[76:77], 1.0 op_sel_hi:[1,1,0]
v_pk_fma_f32 v[64:65], v[64:65], v[76:77], 1.0 op_sel_hi:[1,1,0]
v_pk_fma_f32 v[62:63], v[62:63], v[76:77], 1.0 op_sel_hi:[1,1,0]
v_pk_fma_f32 v[66:67], v[66:67], v[76:77], 1.0 op_sel_hi:[1,1,0]
v_mfma_f32_16x16x32_bf16 v[72:75], v[220:223], v[52:55], v[72:75]
v_cvt_pk_bf16_f32 v80, v60, v61
v_cvt_pk_bf16_f32 v82, v64, v65
v_cvt_pk_bf16_f32 v81, v62, v63
v_cvt_pk_bf16_f32 v83, v66, v67
ds_write_b128 v10, v[80:83]
s_nop 3
v_pk_mul_f32 v[68:69], v[68:69], s[68:69]
v_pk_mul_f32 v[72:73], v[72:73], s[68:69]
v_pk_mul_f32 v[70:71], v[70:71], s[68:69]
v_pk_mul_f32 v[74:75], v[74:75], s[68:69]
v_exp_f32 v68, v68
v_exp_f32 v72, v72
v_exp_f32 v69, v69
v_exp_f32 v73, v73
s_waitcnt lgkmcnt(0)
s_barrier
v_exp_f32 v70, v70
v_exp_f32 v74, v74
v_exp_f32 v71, v71
v_exp_f32 v75, v75
v_pk_add_f32 v[68:69], v[68:69], 1.0 op_sel_hi:[1,0]
v_pk_add_f32 v[72:73], v[72:73], 1.0 op_sel_hi:[1,0]
v_pk_add_f32 v[70:71], v[70:71], 1.0 op_sel_hi:[1,0]
v_pk_add_f32 v[74:75], v[74:75], 1.0 op_sel_hi:[1,0]
v_rcp_f32 v68, v68
v_rcp_f32 v72, v72
v_rcp_f32 v69, v69
v_rcp_f32 v73, v73
v_rcp_f32 v70, v70
v_rcp_f32 v74, v74
v_rcp_f32 v71, v71
v_rcp_f32 v75, v75
v_pk_fma_f32 v[68:69], v[68:69], v[76:77], 1.0 op_sel_hi:[1,1,0]
v_pk_fma_f32 v[72:73], v[72:73], v[76:77], 1.0 op_sel_hi:[1,1,0]
v_pk_fma_f32 v[70:71], v[70:71], v[76:77], 1.0 op_sel_hi:[1,1,0]
v_pk_fma_f32 v[74:75], v[74:75], v[76:77], 1.0 op_sel_hi:[1,1,0]
v_cvt_pk_bf16_f32 v84, v68, v69
v_cvt_pk_bf16_f32 v86, v72, v73
v_cvt_pk_bf16_f32 v85, v70, v71
v_cvt_pk_bf16_f32 v87, v74, v75
ds_write_b128 v10, v[84:87] offset:1024
s_waitcnt lgkmcnt(0)
s_barrier
s_endpgm
L_main_idle:
s_cmp_lg_u32 s2, 127
s_cbranch_scc1 L_end
s_cmp_lg_u32 s3, 0
s_cbranch_scc1 L_end
v_lshlrev_b32 v3, 7, v1
s_mov_b32 s61, 262144
L_bump:
s_mov_b32 s42, 6553600
buffer_load_dword v24, v3, s[12:15], s42 offen sc1
s_mov_b32 s42, 6561792
buffer_load_dword v25, v3, s[12:15], s42 offen sc1
s_mov_b32 s42, 6569984
buffer_load_dword v26, v3, s[12:15], s42 offen sc1
s_mov_b32 s42, 6578176
buffer_load_dword v27, v3, s[12:15], s42 offen sc1
s_sub_u32 s61, s61, 1
s_cbranch_scc1 L_end
s_waitcnt vmcnt(0)
s_mov_b64 s[44:45], 0
v_cmp_ne_u32 vcc, s59, v24
s_or_b64 s[44:45], s[44:45], vcc
v_cmp_ne_u32 vcc, s59, v25
s_or_b64 s[44:45], s[44:45], vcc
v_cmp_ne_u32 vcc, s59, v26
s_or_b64 s[44:45], s[44:45], vcc
v_cmp_ne_u32 vcc, s59, v27
s_or_b64 s[44:45], s[44:45], vcc
s_cmp_lg_u64 s[44:45], 0
s_cbranch_scc1 L_bump
s_mov_b32 s42, 6750208
s_mov_b64 exec, 1
buffer_store_dword v19, off, s[12:15], s42 sc1
s_mov_b64 exec, -1
L_end:
s_endpgm
.p2align 4
L_codeend:
.section .rodata,"a"
.p2align 6
.amdhsa_kernel standalone__seq2seq_rnn_t_joint__speech_kernel
  .amdhsa_next_free_vgpr 256
  .amdhsa_next_free_sgpr 102
  .amdhsa_accum_offset 256
  .amdhsa_group_segment_fixed_size 0
  .amdhsa_kernarg_size 80
  .amdhsa_user_sgpr_count 2
  .amdhsa_user_sgpr_kernarg_segment_ptr 1
  .amdhsa_system_sgpr_workgroup_id_x 1
.end_amdhsa_kernel
```
